```python
import torch

def _softmax(x, axis=-1):
    return torch.softmax(x, dim=axis)
def _gelu(x):
    return torch.nn.functional.gelu(x, approximate="tanh")
def _silu(x):
    return torch.nn.functional.silu(x)
def _sigmoid(x):
    return torch.sigmoid(x)
def _layernorm(x, axis=-1, eps=1e-5):
    m = x.mean(dim=axis, keepdim=True)
    v = x.var(dim=axis, keepdim=True, unbiased=False)
    return (x - m) / torch.sqrt(v + eps)
def _scatter_add(tgt, idx, src, axis=0):
    return tgt.clone().index_add_(axis, idx, src)
def _segment_sum(src, seg, n):
    out = torch.zeros((n,) + src.shape[1:], dtype=src.dtype)
    return out.index_add_(0, seg, src)
def _pad(x, pw):
    flat = tuple(v for pair in reversed(pw) for v in pair)
    return torch.nn.functional.pad(x, flat)

kernel_name = 'parallel_sum__grouped_kv_mqa__dense_activation_silu__prompt'

def setup_inputs():

    _w = (lambda a: (lambda t: t.to(torch.bfloat16) if t.is_floating_point() else t)(torch.as_tensor(a)))
    def _A_setup():
        B, S, D, H = 1, 2048, 640, 32
        Dh = D // H
        return {
            "x": _w((lambda *s: torch.randn(*s, dtype=torch.bfloat16) * 0.05)(B, S, D)),
            "wq": _w((lambda *s: torch.randn(*s, dtype=torch.bfloat16) * 0.05)(D, H * Dh)),
            "wk": _w((lambda *s: torch.randn(*s, dtype=torch.bfloat16) * 0.05)(D, Dh)),
            "wv": _w((lambda *s: torch.randn(*s, dtype=torch.bfloat16) * 0.05)(D, Dh)),
            "wo": _w((lambda *s: torch.randn(*s, dtype=torch.bfloat16) * 0.05)(H * Dh, D)),
        }
    _A_in = _A_setup()

    def _B_setup():
        B, S, D, F = 1, 2048, 640, 1536
        return {
            "x": _w((lambda *s: torch.randn(*s, dtype=torch.bfloat16) * 0.05)(B, S, D)),
            "w1": _w((lambda *s: torch.randn(*s, dtype=torch.bfloat16) * 0.8)(D, F) * (D ** -0.5)),
            "w2": _w((lambda *s: torch.randn(*s, dtype=torch.bfloat16) * 0.8)(F, D) * (F ** -0.5)),
        }
    _B_in = _B_setup()

    return {
        "A_x": _A_in["x"],
        "A_wq": _A_in["wq"],
        "A_wk": _A_in["wk"],
        "A_wv": _A_in["wv"],
        "A_wo": _A_in["wo"],
        "B_x": _B_in["x"],
        "B_w1": _B_in["w1"],
        "B_w2": _B_in["w2"],
    }

def reference(A_x, A_wq, A_wk, A_wv, A_wo, B_x, B_w1, B_w2):
    def _A_ref(x, wq, wk, wv, wo):
        B, S, D = x.shape
        H = 32
        Dh = D // H
        q = (lambda x, *d: x.permute(*d))((x @ wq).reshape(B, S, H, Dh), 0, 2, 1, 3)
        k = x @ wk
        v = x @ wv
        scores = torch.einsum("bhqd,bkd->bhqk", q, k) * (Dh ** -0.5)
        p = _softmax(scores, axis=-1)
        o = torch.einsum("bhqk,bkd->bhqd", p, v)
        return (lambda x, *d: x.permute(*d))(o, 0, 2, 1, 3).reshape(B, S, H * Dh) @ wo

    def _B_ref(x, w1, w2):
        h = torch.einsum("bsd,df->bsf", x, w1)
        h = _silu(h)
        out = torch.einsum("bsf,fd->bsd", h, w2)
        return out

    x = A_x
    xn = _layernorm(x, axis=-1)
    return x + _A_ref(xn, A_wq, A_wk, A_wv, A_wo) + _B_ref(xn, B_w1, B_w2)
```

```asm
; @launch grid=(256,1,1) block=(768,1,1) lds=163840
.amdgcn_target "amdgcn-amd-amdhsa--gfx950"
.text
.globl parallel_sum__grouped_kv_mqa__dense_activation_silu__prompt_kernel
.p2align 8
.type parallel_sum__grouped_kv_mqa__dense_activation_silu__prompt_kernel,@function
parallel_sum__grouped_kv_mqa__dense_activation_silu__prompt_kernel:
L_code_begin:
    s_cmp_ge_u32 s2, 256
    s_cbranch_scc1 L_end
    s_load_dwordx8 s[44:51], s[0:1], 0
    s_load_dwordx2 s[52:53], s[0:1], 32
    s_load_dwordx8 s[56:63], s[0:1], 48
    s_load_dwordx2 s[4:5], s[0:1], 80
    v_and_b32 v1, 63, v0
    v_lshrrev_b32 v2, 6, v0
    v_lshlrev_b32 v30, 4, v1
    v_readfirstlane_b32 s66, v2
    s_and_b32 s20, s2, 7
    s_lshr_b32 s21, s2, 3
    s_getreg_b32 s54, hwreg(HW_REG_XCC_ID, 0, 4)
    s_and_b32 s6, s66, 3
    s_lshr_b32 s7, s66, 2
    s_lshl_b32 s3, s20, 5
    s_add_u32 s3, s3, s21
    s_cmp_ge_u32 s21, 28
    s_cbranch_scc1 L_h_start
    s_lshr_b32 s22, s20, 1
    s_lshl_b32 s22, s22, 2
    s_and_b32 s23, s21, 3
    s_add_u32 s22, s22, s23
    s_and_b32 s23, s20, 1
    s_mul_i32 s23, s23, 5
    s_lshr_b32 s36, s21, 2
    s_add_u32 s23, s23, s36
    s_add_u32 s23, s23, 2
    s_lshl_b32 s30, s20, 1
    s_and_b32 s31, s21, 1
    s_add_u32 s30, s30, s31
    s_lshr_b32 s31, s21, 1
    s_cmp_lt_u32 s21, 8
    s_cselect_b32 s22, s30, s22
    s_cselect_b32 s23, s31, s23
    s_lshl_b32 s29, s22, 2
    s_add_u32 s29, s29, s6
    s_cmp_eq_u32 s7, 0
    s_cbranch_scc1 L_p_cwave
    s_cmp_eq_u32 s7, 1
    s_cbranch_scc1 L_p_idle
    s_setprio 3
    s_and_b32 s39, s21, 3
    s_mul_i32 s39, s39, 0
    s_add_u32 s39, s39, 0
    s_sub_u32 s38, s39, 10
    s_cselect_b32 s39, s39, s38
    v_lshrrev_b32 v2, 3, v1
    v_mul_u32_u24 v2, 1280, v2
    v_lshrrev_b32 v3, 4, v1
    v_and_b32 v32, 7, v1
    v_xor_b32 v33, v32, v3
    v_lshl_add_u32 v4, v33, 4, v2
    v_xor_b32 v33, 4, v33
    v_lshl_add_u32 v5, v33, 4, v2
    s_mul_i32 s42, s29, 40960
    s_lshl_b32 s40, s6, 12
    s_add_u32 s40, s40, 73728
    s_lshl_b32 s41, s6, 10
    s_add_u32 s41, s41, 90112
    s_cmp_lt_u32 s23, 4
    s_mov_b32 s34, 3072
    s_cselect_b32 s34, 1280, s34
    s_sub_u32 s35, s23, 4
    s_cselect_b32 s35, s23, s35
    s_mul_i32 s35, s35, 320
    s_lshl_b32 s30, s6, 6
    s_lshl_b32 s31, s34, 6
    v_add_u32 v32, s30, v1
    v_add_u32 v32, 0, v32
    v_mul_u32_u24 v33, 3277, v32
    v_lshrrev_b32 v34, 16, v33
    v_mul_u32_u24 v33, 20, v34
    v_sub_u32 v40, v32, v33
    v_mul_u32_u24 v33, s34, v34
    v_lshl_add_u32 v33, v40, 4, v33
    v_add_u32 v6, s35, v33
    v_add_u32 v32, s30, v1
    v_add_u32 v32, 256, v32
    v_mul_u32_u24 v33, 3277, v32
    v_lshrrev_b32 v34, 16, v33
    v_mul_u32_u24 v33, 20, v34
    v_sub_u32 v41, v32, v33
    v_mul_u32_u24 v33, s34, v34
    v_lshl_add_u32 v33, v41, 4, v33
    v_add_u32 v7, s35, v33
    v_add_u32 v32, s30, v1
    v_add_u32 v32, 512, v32
    v_mul_u32_u24 v33, 3277, v32
    v_lshrrev_b32 v34, 16, v33
    v_mul_u32_u24 v33, 20, v34
    v_sub_u32 v42, v32, v33
    v_mul_u32_u24 v33, s34, v34
    v_lshl_add_u32 v33, v42, 4, v33
    v_add_u32 v8, s35, v33
    v_add_u32 v32, s30, v1
    v_add_u32 v32, 768, v32
    v_mul_u32_u24 v33, 3277, v32
    v_lshrrev_b32 v34, 16, v33
    v_mul_u32_u24 v33, 20, v34
    v_sub_u32 v43, v32, v33
    v_mul_u32_u24 v33, s34, v34
    v_lshl_add_u32 v33, v43, 4, v33
    v_add_u32 v9, s35, v33
    v_add_u32 v32, s30, v1
    v_add_u32 v32, 1024, v32
    v_mul_u32_u24 v33, 3277, v32
    v_lshrrev_b32 v34, 16, v33
    v_mul_u32_u24 v33, 20, v34
    v_sub_u32 v44, v32, v33
    v_mul_u32_u24 v33, s34, v34
    v_lshl_add_u32 v33, v44, 4, v33
    v_add_u32 v10, s35, v33
    s_cmp_lg_u32 s23, 13
    s_cbranch_scc1 L_p_allp
    v_cmp_gt_u32 vcc, 12, v40
    v_mov_b32 v34, 0x7f000000
    s_nop 0
    v_cndmask_b32 v6, v34, v6, vcc
    v_cmp_gt_u32 vcc, 12, v41
    v_mov_b32 v34, 0x7f000000
    s_nop 0
    v_cndmask_b32 v7, v34, v7, vcc
    v_cmp_gt_u32 vcc, 12, v42
    v_mov_b32 v34, 0x7f000000
    s_nop 0
    v_cndmask_b32 v8, v34, v8, vcc
    v_cmp_gt_u32 vcc, 12, v43
    v_mov_b32 v34, 0x7f000000
    s_nop 0
    v_cndmask_b32 v9, v34, v9, vcc
    v_cmp_gt_u32 vcc, 12, v44
    v_mov_b32 v34, 0x7f000000
    s_nop 0
    v_cndmask_b32 v10, v34, v10, vcc
L_p_allp:
    s_waitcnt lgkmcnt(0)
    s_mov_b32 s12, s44
    s_mov_b32 s13, s45
    s_mov_b32 s14, 2621440
    s_mov_b32 s15, 0x00020000
    s_cmp_lt_u32 s23, 4
    s_cselect_b32 s24, s46, s56
    s_cselect_b32 s25, s47, s57
    s_mov_b32 s26, 1966080
    s_cselect_b32 s26, 819200, s26
    s_mov_b32 s27, 0x00020000
    s_mov_b32 s33, 0
L_p_fill:
    s_lshl_b32 s38, s39, 7
    s_add_u32 s38, s38, s42
    s_mul_i32 s37, s39, s31
    s_mov_b32 m0, s40
    s_mov_b32 s43, s38
    buffer_load_dwordx4 v4, s[12:15], s43 offen lds
    s_add_u32 m0, s40, 1024
    s_add_u32 s43, s38, 10240
    buffer_load_dwordx4 v5, s[12:15], s43 offen lds
    s_add_u32 m0, s40, 2048
    s_add_u32 s43, s38, 20480
    buffer_load_dwordx4 v4, s[12:15], s43 offen lds
    s_add_u32 m0, s40, 3072
    s_add_u32 s43, s38, 30720
    buffer_load_dwordx4 v5, s[12:15], s43 offen lds
    s_mov_b32 m0, s41
    s_nop 0
    buffer_load_dwordx4 v6, s[24:27], s37 offen lds
    s_add_u32 m0, s41, 4096
    s_nop 0
    buffer_load_dwordx4 v7, s[24:27], s37 offen lds
    s_add_u32 m0, s41, 8192
    s_nop 0
    buffer_load_dwordx4 v8, s[24:27], s37 offen lds
    s_add_u32 m0, s41, 12288
    s_nop 0
    buffer_load_dwordx4 v9, s[24:27], s37 offen lds
    s_add_u32 m0, s41, 16384
    s_nop 0
    buffer_load_dwordx4 v10, s[24:27], s37 offen lds
    s_add_u32 s39, s39, 1
    s_cmp_eq_u32 s39, 10
    s_cselect_b32 s39, 0, s39
    s_add_u32 s40, s40, 36864
    s_add_u32 s41, s41, 36864
    s_cmp_ge_u32 s40, 147456
    s_cselect_b32 s43, 147456, 0
    s_sub_u32 s40, s40, s43
    s_sub_u32 s41, s41, s43
    s_add_u32 s33, s33, 1
    s_cmp_lt_u32 s33, 2
    s_cbranch_scc1 L_p_fill
L_p_lloop:
    s_waitcnt vmcnt(9)
    s_barrier
    s_lshl_b32 s38, s39, 7
    s_add_u32 s38, s38, s42
    s_mul_i32 s37, s39, s31
    s_mov_b32 m0, s40
    s_mov_b32 s43, s38
    buffer_load_dwordx4 v4, s[12:15], s43 offen lds
    s_add_u32 m0, s40, 1024
    s_add_u32 s43, s38, 10240
    buffer_load_dwordx4 v5, s[12:15], s43 offen lds
    s_add_u32 m0, s40, 2048
    s_add_u32 s43, s38, 20480
    buffer_load_dwordx4 v4, s[12:15], s43 offen lds
    s_add_u32 m0, s40, 3072
    s_add_u32 s43, s38, 30720
    buffer_load_dwordx4 v5, s[12:15], s43 offen lds
    s_mov_b32 m0, s41
    s_nop 0
    buffer_load_dwordx4 v6, s[24:27], s37 offen lds
    s_add_u32 m0, s41, 4096
    s_nop 0
    buffer_load_dwordx4 v7, s[24:27], s37 offen lds
    s_add_u32 m0, s41, 8192
    s_nop 0
    buffer_load_dwordx4 v8, s[24:27], s37 offen lds
    s_add_u32 m0, s41, 12288
    s_nop 0
    buffer_load_dwordx4 v9, s[24:27], s37 offen lds
    s_add_u32 m0, s41, 16384
    s_nop 0
    buffer_load_dwordx4 v10, s[24:27], s37 offen lds
    s_add_u32 s39, s39, 1
    s_cmp_eq_u32 s39, 10
    s_cselect_b32 s39, 0, s39
    s_add_u32 s40, s40, 36864
    s_add_u32 s41, s41, 36864
    s_cmp_ge_u32 s40, 147456
    s_cselect_b32 s43, 147456, 0
    s_sub_u32 s40, s40, s43
    s_sub_u32 s41, s41, s43
    s_add_u32 s33, s33, 1
    s_cmp_lt_u32 s33, 10
    s_cbranch_scc1 L_p_lloop
    s_mov_b32 s8, s4
    s_mov_b32 s9, s5
    s_mov_b32 s10, 15204352
    s_mov_b32 s11, 0x00020000
    s_mov_b32 s16, s62
    s_mov_b32 s17, s63
    s_mov_b32 s18, 256
    s_mov_b32 s19, 0x00020000
    s_waitcnt vmcnt(9)
    s_barrier
    s_waitcnt vmcnt(0)
    s_barrier
    s_mov_b32 s39, 4
    s_branch L_a_start
L_p_idle:
    v_mov_b32 v32, 163584
    v_mov_b32 v36, 0
    v_mov_b32 v37, 0
    v_mov_b32 v38, 0
    v_mov_b32 v39, 0
    ds_write_b128 v32, v[36:39] offset:0
    ds_write_b128 v32, v[36:39] offset:16
    ds_write_b128 v32, v[36:39] offset:32
    ds_write_b128 v32, v[36:39] offset:48
    ds_write_b128 v32, v[36:39] offset:64
    ds_write_b128 v32, v[36:39] offset:80
    v_mov_b32 v44, 0
    s_waitcnt lgkmcnt(0)
    s_mov_b32 s8, s4
    s_mov_b32 s9, s5
    s_mov_b32 s10, 15204352
    s_mov_b32 s11, 0x00020000
    s_mov_b32 s16, s62
    s_mov_b32 s17, s63
    s_mov_b32 s18, 256
    s_mov_b32 s19, 0x00020000
    s_or_b32 s30, s2, s6
    s_cmp_lg_u32 s30, 0
    s_cbranch_scc1 L_p_idle1
    s_memrealtime s[64:65]
    s_waitcnt lgkmcnt(0)
    s_or_b32 s64, s64, 1
    v_mov_b32 v46, s64
    v_mov_b32 v47, 0
    s_mov_b64 exec, 1
    buffer_atomic_cmpswap v[46:47], v44, s[16:19], 0 offen sc1
    s_mov_b64 exec, -1
    s_nop 1
L_p_idle1:
    s_setprio 2
    s_and_b32 s30, s21, 7
    s_or_b32 s30, s30, s6
    s_cmp_lg_u32 s30, 0
    s_cbranch_scc1 L_p_idle1b
    s_getpc_b64 s[34:35]
L_p_pc:
    s_sub_u32 s34, s34, L_p_pc - L_code_begin
    s_subb_u32 s35, s35, 0
    v_lshlrev_b32 v46, 7, v1
    v_min_u32 v47, L_code_end - L_code_begin - 4, v46
    global_load_dword v160, v47, s[34:35]
    v_add_u32 v46, 8192, v46
    v_min_u32 v47, L_code_end - L_code_begin - 4, v46
    global_load_dword v161, v47, s[34:35]
    v_add_u32 v46, 8192, v46
    v_min_u32 v47, L_code_end - L_code_begin - 4, v46
    global_load_dword v162, v47, s[34:35]
    v_add_u32 v46, 8192, v46
    v_min_u32 v47, L_code_end - L_code_begin - 4, v46
    global_load_dword v163, v47, s[34:35]
    v_add_u32 v46, 8192, v46
    v_min_u32 v47, L_code_end - L_code_begin - 4, v46
    global_load_dword v164, v47, s[34:35]
    v_add_u32 v46, 8192, v46
L_p_idle1b:
    s_lshr_b32 s30, s22, 1
    s_sub_u32 s31, s23, 13
    s_or_b32 s37, s30, s31
    s_add_u32 s22, s22, 32
    s_lshr_b32 s38, s2, 2
    s_mul_i32 s38, s38, 3
    s_add_u32 s38, s38, s6
    s_sub_u32 s38, s38, 1
    s_cmp_eq_u32 s6, 0
    s_cselect_b32 s38, 999, s38
    s_and_b32 s39, s2, 3
    s_cmp_lt_u32 s38, 40
    s_cselect_b32 s12, s52, s58
    s_cselect_b32 s13, s53, s59
    s_mov_b32 s14, 1966080
    s_cselect_b32 s14, 819200, s14
    s_mov_b32 s15, 0x00020000
    s_mov_b32 s40, 0x3020100
    s_cmp_lt_u32 s38, 40
    s_cselect_b32 s40, 0x1f1e0b0a, s40
    s_cmp_lt_u32 s38, 32
    s_cselect_b32 s40, 0x3020100, s40
    s_mov_b32 s41, 0xb0a0908
    s_cmp_lt_u32 s38, 40
    s_cselect_b32 s41, 0x47463332, s41
    s_cmp_lt_u32 s38, 32
    s_cselect_b32 s41, 0xf0e0d0c, s41
    s_mov_b32 s42, 0x7060504
    s_cmp_lt_u32 s38, 40
    s_cselect_b32 s42, 0x1d1c0908, s42
    s_cmp_lt_u32 s38, 32
    s_cselect_b32 s42, 0x13121110, s42
    s_mov_b32 s43, 0xf0e0d0c
    s_cmp_lt_u32 s38, 40
    s_cselect_b32 s43, 0x45443130, s43
    s_cmp_lt_u32 s38, 32
    s_cselect_b32 s43, 0x7060504, s43
    s_sub_u32 s34, s38, 40
    s_lshl_b32 s34, s34, 4
    s_sub_u32 s35, s38, 32
    s_mul_i32 s35, s35, 80
    s_cmp_lt_u32 s38, 40
    s_cselect_b32 s34, s35, s34
    s_mul_i32 s35, s38, 20
    s_cmp_lt_u32 s38, 32
    s_cselect_b32 s34, s35, s34
    s_mul_i32 s34, s34, 1280
    s_mul_i32 s35, s39, 320
    s_add_u32 s33, s34, s35
    v_mov_b32 v36, s40
    v_mov_b32 v37, s42
    s_mov_b32 s30, 0
    v_add_u32 v32, s30, v1
    v_add_u32 v32, 0, v32
    v_mul_u32_u24 v33, 3277, v32
    v_lshrrev_b32 v34, 16, v33
    v_mul_u32_u24 v33, 20, v34
    v_sub_u32 v35, v32, v33
    v_and_b32 v33, 7, v34
    v_or_b32 v33, 0x0c0c0c00, v33
    v_perm_b32 v38, s41, v36, v33
    v_perm_b32 v39, s43, v37, v33
    v_cmp_lt_u32 vcc, 7, v34
    s_nop 1
    v_cndmask_b32 v38, v38, v39, vcc
    v_mul_u32_u24 v38, 1280, v38
    v_lshl_add_u32 v8, v35, 4, v38
    v_add_u32 v32, s30, v1
    v_add_u32 v32, 64, v32
    v_mul_u32_u24 v33, 3277, v32
    v_lshrrev_b32 v34, 16, v33
    v_mul_u32_u24 v33, 20, v34
    v_sub_u32 v35, v32, v33
    v_and_b32 v33, 7, v34
    v_or_b32 v33, 0x0c0c0c00, v33
    v_perm_b32 v38, s41, v36, v33
    v_perm_b32 v39, s43, v37, v33
    v_cmp_lt_u32 vcc, 7, v34
    s_nop 1
    v_cndmask_b32 v38, v38, v39, vcc
    v_mul_u32_u24 v38, 1280, v38
    v_lshl_add_u32 v9, v35, 4, v38
    v_add_u32 v32, s30, v1
    v_add_u32 v32, 128, v32
    v_mul_u32_u24 v33, 3277, v32
    v_lshrrev_b32 v34, 16, v33
    v_mul_u32_u24 v33, 20, v34
    v_sub_u32 v35, v32, v33
    v_and_b32 v33, 7, v34
    v_or_b32 v33, 0x0c0c0c00, v33
    v_perm_b32 v38, s41, v36, v33
    v_perm_b32 v39, s43, v37, v33
    v_cmp_lt_u32 vcc, 7, v34
    s_nop 1
    v_cndmask_b32 v38, v38, v39, vcc
    v_mul_u32_u24 v38, 1280, v38
    v_lshl_add_u32 v10, v35, 4, v38
    v_add_u32 v32, s30, v1
    v_add_u32 v32, 192, v32
    v_mul_u32_u24 v33, 3277, v32
    v_lshrrev_b32 v34, 16, v33
    v_mul_u32_u24 v33, 20, v34
    v_sub_u32 v35, v32, v33
    v_and_b32 v33, 7, v34
    v_or_b32 v33, 0x0c0c0c00, v33
    v_perm_b32 v38, s41, v36, v33
    v_perm_b32 v39, s43, v37, v33
    v_cmp_lt_u32 vcc, 7, v34
    s_nop 1
    v_cndmask_b32 v38, v38, v39, vcc
    v_mul_u32_u24 v38, 1280, v38
    v_lshl_add_u32 v11, v35, 4, v38
    v_add_u32 v32, s30, v1
    v_add_u32 v32, 256, v32
    v_mul_u32_u24 v33, 3277, v32
    v_lshrrev_b32 v34, 16, v33
    v_mul_u32_u24 v33, 20, v34
    v_sub_u32 v35, v32, v33
    v_and_b32 v33, 7, v34
    v_or_b32 v33, 0x0c0c0c00, v33
    v_perm_b32 v38, s41, v36, v33
    v_perm_b32 v39, s43, v37, v33
    v_cmp_lt_u32 vcc, 7, v34
    s_nop 1
    v_cndmask_b32 v38, v38, v39, vcc
    v_mul_u32_u24 v38, 1280, v38
    v_lshl_add_u32 v12, v35, 4, v38
    s_mul_i32 s29, s6, 5120
    s_add_u32 s29, s29, 142336
    s_cmp_lg_u32 s37, 0
    s_cbranch_scc1 L_p_idle2
    v_lshrrev_b32 v2, 3, v1
    v_and_b32 v3, 7, v1
    s_cmp_lt_u32 s22, 10
    s_cselect_b32 s24, s46, s56
    s_cselect_b32 s25, s47, s57
    s_mov_b32 s26, 1966080
    s_cselect_b32 s26, 819200, s26
    s_mov_b32 s27, 0x00020000
    s_mov_b32 s34, 3072
    s_cselect_b32 s34, 1280, s34
    s_sub_u32 s35, s22, 10
    s_cselect_b32 s35, s22, s35
    s_lshl_b32 s35, s35, 7
    s_mul_i32 s30, s6, 160
    s_mul_i32 s30, s30, s34
    s_add_u32 s30, s30, s35
    s_lshl_b32 s31, s34, 3
    v_mul_u32_u24 v4, s34, v2
    v_lshl_add_u32 v4, v3, 4, v4
    buffer_load_dwordx4 v[48:51], v4, s[24:27], s30 offen
    s_add_u32 s30, s30, s31
    buffer_load_dwordx4 v[52:55], v4, s[24:27], s30 offen
    s_add_u32 s30, s30, s31
    buffer_load_dwordx4 v[56:59], v4, s[24:27], s30 offen
    s_add_u32 s30, s30, s31
    buffer_load_dwordx4 v[60:63], v4, s[24:27], s30 offen
    s_add_u32 s30, s30, s31
    buffer_load_dwordx4 v[64:67], v4, s[24:27], s30 offen
    s_add_u32 s30, s30, s31
    buffer_load_dwordx4 v[68:71], v4, s[24:27], s30 offen
    s_add_u32 s30, s30, s31
    buffer_load_dwordx4 v[72:75], v4, s[24:27], s30 offen
    s_add_u32 s30, s30, s31
    buffer_load_dwordx4 v[76:79], v4, s[24:27], s30 offen
    s_add_u32 s30, s30, s31
    buffer_load_dwordx4 v[80:83], v4, s[24:27], s30 offen
    s_add_u32 s30, s30, s31
    buffer_load_dwordx4 v[84:87], v4, s[24:27], s30 offen
    s_add_u32 s30, s30, s31
    buffer_load_dwordx4 v[88:91], v4, s[24:27], s30 offen
    s_add_u32 s30, s30, s31
    buffer_load_dwordx4 v[92:95], v4, s[24:27], s30 offen
    s_add_u32 s30, s30, s31
    buffer_load_dwordx4 v[96:99], v4, s[24:27], s30 offen
    s_add_u32 s30, s30, s31
    buffer_load_dwordx4 v[100:103], v4, s[24:27], s30 offen
    s_add_u32 s30, s30, s31
    buffer_load_dwordx4 v[104:107], v4, s[24:27], s30 offen
    s_add_u32 s30, s30, s31
    buffer_load_dwordx4 v[108:111], v4, s[24:27], s30 offen
    s_add_u32 s30, s30, s31
    buffer_load_dwordx4 v[112:115], v4, s[24:27], s30 offen
    s_add_u32 s30, s30, s31
    buffer_load_dwordx4 v[116:119], v4, s[24:27], s30 offen
    s_add_u32 s30, s30, s31
    buffer_load_dwordx4 v[120:123], v4, s[24:27], s30 offen
    s_add_u32 s30, s30, s31
    buffer_load_dwordx4 v[124:127], v4, s[24:27], s30 offen
    s_add_u32 s30, s30, s31
L_p_idle2:
    s_barrier
    buffer_load_dword v46, v44, s[16:19], 0 offen sc1
    s_barrier
    s_barrier
    s_waitcnt vmcnt(0)
    v_readfirstlane_b32 s64, v46
    s_cmp_lg_u32 s64, 0
    s_cbranch_scc1 L_p_tag2_ok
    s_mov_b32 s28, 0
L_p_tag2:
    buffer_load_dword v46, v44, s[16:19], 0 offen sc1
    s_add_u32 s28, s28, 1
    s_waitcnt vmcnt(0)
    v_readfirstlane_b32 s64, v46
    s_cmp_lg_u32 s64, 0
    s_cbranch_scc1 L_p_tag2_ok
    s_sleep 2
    s_cmp_lt_u32 s28, 131072
    s_cbranch_scc1 L_p_tag2
L_p_tag2_ok:
    s_cmp_lg_u32 s6, 0
    s_cbranch_scc1 L_p_nox
    s_lshr_b32 s30, s3, 2
    s_mul_i32 s30, s30, 4224
    s_add_u32 s30, s30, 14781440
    s_and_b32 s31, s3, 3
    s_lshl_b32 s31, s31, 3
    s_add_u32 s30, s30, s31
    v_mov_b32 v46, s64
    v_mov_b32 v47, s54
    s_mov_b64 exec, 1
    buffer_store_dwordx2 v[46:47], off, s[8:11], s30 offset:64 sc1
    s_mov_b64 exec, -1
L_p_nox:
    s_cmp_lg_u32 s37, 0
    s_cbranch_scc1 L_p_idle2b
    v_mov_b32 v128, 0
    v_mov_b32 v129, 0
    v_mov_b32 v130, 0
    v_mov_b32 v131, 0
    v_mov_b32 v132, 0
    v_mov_b32 v133, 0
    v_mov_b32 v134, 0
    v_mov_b32 v135, 0
    v_lshlrev_b32 v136, 16, v48
    v_and_b32 v137, 0xffff0000, v48
    v_lshlrev_b32 v138, 16, v49
    v_and_b32 v139, 0xffff0000, v49
    v_lshlrev_b32 v140, 16, v50
    v_and_b32 v141, 0xffff0000, v50
    v_lshlrev_b32 v142, 16, v51
    v_and_b32 v143, 0xffff0000, v51
    v_add_f32 v128, v128, v136
    v_add_f32 v129, v129, v137
    v_add_f32 v130, v130, v138
    v_add_f32 v131, v131, v139
    v_add_f32 v132, v132, v140
    v_add_f32 v133, v133, v141
    v_add_f32 v134, v134, v142
    v_add_f32 v135, v135, v143
    v_lshlrev_b32 v136, 16, v52
    v_and_b32 v137, 0xffff0000, v52
    v_lshlrev_b32 v138, 16, v53
    v_and_b32 v139, 0xffff0000, v53
    v_lshlrev_b32 v140, 16, v54
    v_and_b32 v141, 0xffff0000, v54
    v_lshlrev_b32 v142, 16, v55
    v_and_b32 v143, 0xffff0000, v55
    v_add_f32 v128, v128, v136
    v_add_f32 v129, v129, v137
    v_add_f32 v130, v130, v138
    v_add_f32 v131, v131, v139
    v_add_f32 v132, v132, v140
    v_add_f32 v133, v133, v141
    v_add_f32 v134, v134, v142
    v_add_f32 v135, v135, v143
    v_lshlrev_b32 v136, 16, v56
    v_and_b32 v137, 0xffff0000, v56
    v_lshlrev_b32 v138, 16, v57
    v_and_b32 v139, 0xffff0000, v57
    v_lshlrev_b32 v140, 16, v58
    v_and_b32 v141, 0xffff0000, v58
    v_lshlrev_b32 v142, 16, v59
    v_and_b32 v143, 0xffff0000, v59
    v_add_f32 v128, v128, v136
    v_add_f32 v129, v129, v137
    v_add_f32 v130, v130, v138
    v_add_f32 v131, v131, v139
    v_add_f32 v132, v132, v140
    v_add_f32 v133, v133, v141
    v_add_f32 v134, v134, v142
    v_add_f32 v135, v135, v143
    v_lshlrev_b32 v136, 16, v60
    v_and_b32 v137, 0xffff0000, v60
    v_lshlrev_b32 v138, 16, v61
    v_and_b32 v139, 0xffff0000, v61
    v_lshlrev_b32 v140, 16, v62
    v_and_b32 v141, 0xffff0000, v62
    v_lshlrev_b32 v142, 16, v63
    v_and_b32 v143, 0xffff0000, v63
    v_add_f32 v128, v128, v136
    v_add_f32 v129, v129, v137
    v_add_f32 v130, v130, v138
    v_add_f32 v131, v131, v139
    v_add_f32 v132, v132, v140
    v_add_f32 v133, v133, v141
    v_add_f32 v134, v134, v142
    v_add_f32 v135, v135, v143
    v_lshlrev_b32 v136, 16, v64
    v_and_b32 v137, 0xffff0000, v64
    v_lshlrev_b32 v138, 16, v65
    v_and_b32 v139, 0xffff0000, v65
    v_lshlrev_b32 v140, 16, v66
    v_and_b32 v141, 0xffff0000, v66
    v_lshlrev_b32 v142, 16, v67
    v_and_b32 v143, 0xffff0000, v67
    v_add_f32 v128, v128, v136
    v_add_f32 v129, v129, v137
    v_add_f32 v130, v130, v138
    v_add_f32 v131, v131, v139
    v_add_f32 v132, v132, v140
    v_add_f32 v133, v133, v141
    v_add_f32 v134, v134, v142
    v_add_f32 v135, v135, v143
    v_lshlrev_b32 v136, 16, v68
    v_and_b32 v137, 0xffff0000, v68
    v_lshlrev_b32 v138, 16, v69
    v_and_b32 v139, 0xffff0000, v69
    v_lshlrev_b32 v140, 16, v70
    v_and_b32 v141, 0xffff0000, v70
    v_lshlrev_b32 v142, 16, v71
    v_and_b32 v143, 0xffff0000, v71
    v_add_f32 v128, v128, v136
    v_add_f32 v129, v129, v137
    v_add_f32 v130, v130, v138
    v_add_f32 v131, v131, v139
    v_add_f32 v132, v132, v140
    v_add_f32 v133, v133, v141
    v_add_f32 v134, v134, v142
    v_add_f32 v135, v135, v143
    v_lshlrev_b32 v136, 16, v72
    v_and_b32 v137, 0xffff0000, v72
    v_lshlrev_b32 v138, 16, v73
    v_and_b32 v139, 0xffff0000, v73
    v_lshlrev_b32 v140, 16, v74
    v_and_b32 v141, 0xffff0000, v74
    v_lshlrev_b32 v142, 16, v75
    v_and_b32 v143, 0xffff0000, v75
    v_add_f32 v128, v128, v136
    v_add_f32 v129, v129, v137
    v_add_f32 v130, v130, v138
    v_add_f32 v131, v131, v139
    v_add_f32 v132, v132, v140
    v_add_f32 v133, v133, v141
    v_add_f32 v134, v134, v142
    v_add_f32 v135, v135, v143
    v_lshlrev_b32 v136, 16, v76
    v_and_b32 v137, 0xffff0000, v76
    v_lshlrev_b32 v138, 16, v77
    v_and_b32 v139, 0xffff0000, v77
    v_lshlrev_b32 v140, 16, v78
    v_and_b32 v141, 0xffff0000, v78
    v_lshlrev_b32 v142, 16, v79
    v_and_b32 v143, 0xffff0000, v79
    v_add_f32 v128, v128, v136
    v_add_f32 v129, v129, v137
    v_add_f32 v130, v130, v138
    v_add_f32 v131, v131, v139
    v_add_f32 v132, v132, v140
    v_add_f32 v133, v133, v141
    v_add_f32 v134, v134, v142
    v_add_f32 v135, v135, v143
    v_lshlrev_b32 v136, 16, v80
    v_and_b32 v137, 0xffff0000, v80
    v_lshlrev_b32 v138, 16, v81
    v_and_b32 v139, 0xffff0000, v81
    v_lshlrev_b32 v140, 16, v82
    v_and_b32 v141, 0xffff0000, v82
    v_lshlrev_b32 v142, 16, v83
    v_and_b32 v143, 0xffff0000, v83
    v_add_f32 v128, v128, v136
    v_add_f32 v129, v129, v137
    v_add_f32 v130, v130, v138
    v_add_f32 v131, v131, v139
    v_add_f32 v132, v132, v140
    v_add_f32 v133, v133, v141
    v_add_f32 v134, v134, v142
    v_add_f32 v135, v135, v143
    v_lshlrev_b32 v136, 16, v84
    v_and_b32 v137, 0xffff0000, v84
    v_lshlrev_b32 v138, 16, v85
    v_and_b32 v139, 0xffff0000, v85
    v_lshlrev_b32 v140, 16, v86
    v_and_b32 v141, 0xffff0000, v86
    v_lshlrev_b32 v142, 16, v87
    v_and_b32 v143, 0xffff0000, v87
    v_add_f32 v128, v128, v136
    v_add_f32 v129, v129, v137
    v_add_f32 v130, v130, v138
    v_add_f32 v131, v131, v139
    v_add_f32 v132, v132, v140
    v_add_f32 v133, v133, v141
    v_add_f32 v134, v134, v142
    v_add_f32 v135, v135, v143
    v_lshlrev_b32 v136, 16, v88
    v_and_b32 v137, 0xffff0000, v88
    v_lshlrev_b32 v138, 16, v89
    v_and_b32 v139, 0xffff0000, v89
    v_lshlrev_b32 v140, 16, v90
    v_and_b32 v141, 0xffff0000, v90
    v_lshlrev_b32 v142, 16, v91
    v_and_b32 v143, 0xffff0000, v91
    v_add_f32 v128, v128, v136
    v_add_f32 v129, v129, v137
    v_add_f32 v130, v130, v138
    v_add_f32 v131, v131, v139
    v_add_f32 v132, v132, v140
    v_add_f32 v133, v133, v141
    v_add_f32 v134, v134, v142
    v_add_f32 v135, v135, v143
    v_lshlrev_b32 v136, 16, v92
    v_and_b32 v137, 0xffff0000, v92
    v_lshlrev_b32 v138, 16, v93
    v_and_b32 v139, 0xffff0000, v93
    v_lshlrev_b32 v140, 16, v94
    v_and_b32 v141, 0xffff0000, v94
    v_lshlrev_b32 v142, 16, v95
    v_and_b32 v143, 0xffff0000, v95
    v_add_f32 v128, v128, v136
    v_add_f32 v129, v129, v137
    v_add_f32 v130, v130, v138
    v_add_f32 v131, v131, v139
    v_add_f32 v132, v132, v140
    v_add_f32 v133, v133, v141
    v_add_f32 v134, v134, v142
    v_add_f32 v135, v135, v143
    v_lshlrev_b32 v136, 16, v96
    v_and_b32 v137, 0xffff0000, v96
    v_lshlrev_b32 v138, 16, v97
    v_and_b32 v139, 0xffff0000, v97
    v_lshlrev_b32 v140, 16, v98
    v_and_b32 v141, 0xffff0000, v98
    v_lshlrev_b32 v142, 16, v99
    v_and_b32 v143, 0xffff0000, v99
    v_add_f32 v128, v128, v136
    v_add_f32 v129, v129, v137
    v_add_f32 v130, v130, v138
    v_add_f32 v131, v131, v139
    v_add_f32 v132, v132, v140
    v_add_f32 v133, v133, v141
    v_add_f32 v134, v134, v142
    v_add_f32 v135, v135, v143
    v_lshlrev_b32 v136, 16, v100
    v_and_b32 v137, 0xffff0000, v100
    v_lshlrev_b32 v138, 16, v101
    v_and_b32 v139, 0xffff0000, v101
    v_lshlrev_b32 v140, 16, v102
    v_and_b32 v141, 0xffff0000, v102
    v_lshlrev_b32 v142, 16, v103
    v_and_b32 v143, 0xffff0000, v103
    v_add_f32 v128, v128, v136
    v_add_f32 v129, v129, v137
    v_add_f32 v130, v130, v138
    v_add_f32 v131, v131, v139
    v_add_f32 v132, v132, v140
    v_add_f32 v133, v133, v141
    v_add_f32 v134, v134, v142
    v_add_f32 v135, v135, v143
    v_lshlrev_b32 v136, 16, v104
    v_and_b32 v137, 0xffff0000, v104
    v_lshlrev_b32 v138, 16, v105
    v_and_b32 v139, 0xffff0000, v105
    v_lshlrev_b32 v140, 16, v106
    v_and_b32 v141, 0xffff0000, v106
    v_lshlrev_b32 v142, 16, v107
    v_and_b32 v143, 0xffff0000, v107
    v_add_f32 v128, v128, v136
    v_add_f32 v129, v129, v137
    v_add_f32 v130, v130, v138
    v_add_f32 v131, v131, v139
    v_add_f32 v132, v132, v140
    v_add_f32 v133, v133, v141
    v_add_f32 v134, v134, v142
    v_add_f32 v135, v135, v143
    v_lshlrev_b32 v136, 16, v108
    v_and_b32 v137, 0xffff0000, v108
    v_lshlrev_b32 v138, 16, v109
    v_and_b32 v139, 0xffff0000, v109
    v_lshlrev_b32 v140, 16, v110
    v_and_b32 v141, 0xffff0000, v110
    v_lshlrev_b32 v142, 16, v111
    v_and_b32 v143, 0xffff0000, v111
    v_add_f32 v128, v128, v136
    v_add_f32 v129, v129, v137
    v_add_f32 v130, v130, v138
    v_add_f32 v131, v131, v139
    v_add_f32 v132, v132, v140
    v_add_f32 v133, v133, v141
    v_add_f32 v134, v134, v142
    v_add_f32 v135, v135, v143
    v_lshlrev_b32 v136, 16, v112
    v_and_b32 v137, 0xffff0000, v112
    v_lshlrev_b32 v138, 16, v113
    v_and_b32 v139, 0xffff0000, v113
    v_lshlrev_b32 v140, 16, v114
    v_and_b32 v141, 0xffff0000, v114
    v_lshlrev_b32 v142, 16, v115
    v_and_b32 v143, 0xffff0000, v115
    v_add_f32 v128, v128, v136
    v_add_f32 v129, v129, v137
    v_add_f32 v130, v130, v138
    v_add_f32 v131, v131, v139
    v_add_f32 v132, v132, v140
    v_add_f32 v133, v133, v141
    v_add_f32 v134, v134, v142
    v_add_f32 v135, v135, v143
    v_lshlrev_b32 v136, 16, v116
    v_and_b32 v137, 0xffff0000, v116
    v_lshlrev_b32 v138, 16, v117
    v_and_b32 v139, 0xffff0000, v117
    v_lshlrev_b32 v140, 16, v118
    v_and_b32 v141, 0xffff0000, v118
    v_lshlrev_b32 v142, 16, v119
    v_and_b32 v143, 0xffff0000, v119
    v_add_f32 v128, v128, v136
    v_add_f32 v129, v129, v137
    v_add_f32 v130, v130, v138
    v_add_f32 v131, v131, v139
    v_add_f32 v132, v132, v140
    v_add_f32 v133, v133, v141
    v_add_f32 v134, v134, v142
    v_add_f32 v135, v135, v143
    v_lshlrev_b32 v136, 16, v120
    v_and_b32 v137, 0xffff0000, v120
    v_lshlrev_b32 v138, 16, v121
    v_and_b32 v139, 0xffff0000, v121
    v_lshlrev_b32 v140, 16, v122
    v_and_b32 v141, 0xffff0000, v122
    v_lshlrev_b32 v142, 16, v123
    v_and_b32 v143, 0xffff0000, v123
    v_add_f32 v128, v128, v136
    v_add_f32 v129, v129, v137
    v_add_f32 v130, v130, v138
    v_add_f32 v131, v131, v139
    v_add_f32 v132, v132, v140
    v_add_f32 v133, v133, v141
    v_add_f32 v134, v134, v142
    v_add_f32 v135, v135, v143
    v_lshlrev_b32 v136, 16, v124
    v_and_b32 v137, 0xffff0000, v124
    v_lshlrev_b32 v138, 16, v125
    v_and_b32 v139, 0xffff0000, v125
    v_lshlrev_b32 v140, 16, v126
    v_and_b32 v141, 0xffff0000, v126
    v_lshlrev_b32 v142, 16, v127
    v_and_b32 v143, 0xffff0000, v127
    v_add_f32 v128, v128, v136
    v_add_f32 v129, v129, v137
    v_add_f32 v130, v130, v138
    v_add_f32 v131, v131, v139
    v_add_f32 v132, v132, v140
    v_add_f32 v133, v133, v141
    v_add_f32 v134, v134, v142
    v_add_f32 v135, v135, v143
    s_lshl_b32 s36, s6, 11
    s_add_u32 s36, s36, 147456
    v_lshlrev_b32 v5, 5, v1
    v_add_u32 v5, s36, v5
    ds_write_b128 v5, v[128:131]
    ds_write_b128 v5, v[132:135] offset:16
    s_waitcnt lgkmcnt(0)
    v_mov_b32 v6, 163584
    v_mov_b32 v7, 1
    s_mov_b64 exec, 1
    ds_add_rtn_u32 v8, v6, v7 offset:36
    s_waitcnt lgkmcnt(0)
    v_readfirstlane_b32 s27, v8
    s_mov_b64 exec, -1
    s_cmp_lg_u32 s27, 3
    s_cbranch_scc1 L_p_idle2b
    v_lshlrev_b32 v5, 2, v1
    v_add_u32 v6, 147456, v5
    ds_read_b32 v48, v6 offset:0
    ds_read_b32 v49, v6 offset:256
    ds_read_b32 v50, v6 offset:512
    ds_read_b32 v51, v6 offset:768
    ds_read_b32 v52, v6 offset:1024
    ds_read_b32 v53, v6 offset:1280
    ds_read_b32 v54, v6 offset:1536
    ds_read_b32 v55, v6 offset:1792
    s_waitcnt lgkmcnt(4)
    ds_read_b32 v56, v6 offset:2048
    ds_read_b32 v57, v6 offset:2304
    ds_read_b32 v58, v6 offset:2560
    ds_read_b32 v59, v6 offset:2816
    ds_read_b32 v60, v6 offset:3072
    ds_read_b32 v61, v6 offset:3328
    ds_read_b32 v62, v6 offset:3584
    ds_read_b32 v63, v6 offset:3840
    s_waitcnt lgkmcnt(4)
    ds_read_b32 v64, v6 offset:4096
    ds_read_b32 v65, v6 offset:4352
    ds_read_b32 v66, v6 offset:4608
    ds_read_b32 v67, v6 offset:4864
    ds_read_b32 v68, v6 offset:5120
    ds_read_b32 v69, v6 offset:5376
    ds_read_b32 v70, v6 offset:5632
    ds_read_b32 v71, v6 offset:5888
    s_waitcnt lgkmcnt(4)
    ds_read_b32 v72, v6 offset:6144
    ds_read_b32 v73, v6 offset:6400
    ds_read_b32 v74, v6 offset:6656
    ds_read_b32 v75, v6 offset:6912
    ds_read_b32 v76, v6 offset:7168
    ds_read_b32 v77, v6 offset:7424
    ds_read_b32 v78, v6 offset:7680
    ds_read_b32 v79, v6 offset:7936
    s_waitcnt lgkmcnt(4)
    s_waitcnt lgkmcnt(0)
    v_add_f32 v48, v48, v64
    v_add_f32 v49, v49, v65
    v_add_f32 v50, v50, v66
    v_add_f32 v51, v51, v67
    v_add_f32 v52, v52, v68
    v_add_f32 v53, v53, v69
    v_add_f32 v54, v54, v70
    v_add_f32 v55, v55, v71
    v_add_f32 v56, v56, v72
    v_add_f32 v57, v57, v73
    v_add_f32 v58, v58, v74
    v_add_f32 v59, v59, v75
    v_add_f32 v60, v60, v76
    v_add_f32 v61, v61, v77
    v_add_f32 v62, v62, v78
    v_add_f32 v63, v63, v79
    v_add_f32 v48, v48, v56
    v_add_f32 v49, v49, v57
    v_add_f32 v50, v50, v58
    v_add_f32 v51, v51, v59
    v_add_f32 v52, v52, v60
    v_add_f32 v53, v53, v61
    v_add_f32 v54, v54, v62
    v_add_f32 v55, v55, v63
    v_add_f32 v48, v48, v52
    v_add_f32 v49, v49, v53
    v_add_f32 v50, v50, v54
    v_add_f32 v51, v51, v55
    v_add_f32 v48, v48, v50
    v_add_f32 v49, v49, v51
    v_add_f32 v48, v48, v49
    v_cvt_pk_bf16_f32 v49, v48, v48
    v_and_b32 v49, 0xffff0000, v49
    v_sub_f32 v49, v48, v49
    v_cvt_pk_bf16_f32 v50, v48, v49
    v_mov_b32 v51, s64
    v_lshlrev_b32 v5, 3, v1
    s_lshl_b32 s30, s22, 9
    s_add_u32 s30, s30, 14594048
    buffer_store_dwordx2 v[50:51], v5, s[8:11], s30 offen sc1
L_p_idle2b:
    s_barrier
    s_barrier
    s_cmp_ge_u32 s38, 136
    s_cbranch_scc1 L_p_norl2
    s_mov_b32 m0, s29
    s_nop 0
    buffer_load_dwordx4 v8, s[12:15], s33 offen lds
    s_add_u32 m0, s29, 1024
    s_nop 0
    buffer_load_dwordx4 v9, s[12:15], s33 offen lds
    s_add_u32 m0, s29, 2048
    s_nop 0
    buffer_load_dwordx4 v10, s[12:15], s33 offen lds
    s_add_u32 m0, s29, 3072
    s_nop 0
    buffer_load_dwordx4 v11, s[12:15], s33 offen lds
    s_add_u32 m0, s29, 4096
    s_nop 0
    buffer_load_dwordx4 v12, s[12:15], s33 offen lds
L_p_norl2:
    v_bfe_u32 v33, v1, 4, 1
    v_and_b32 v34, 3, v1
    v_lshl_add_u32 v33, v33, 2, v34
    v_or_b32 v33, 0x0c0c0c00, v33
    v_mov_b32 v34, 0x5010400
    v_mov_b32 v35, 0x7030602
    v_perm_b32 v34, v35, v34, v33
    v_lshrrev_b32 v35, 5, v1
    v_bfe_u32 v32, v1, 2, 2
    v_lshl_add_u32 v32, v35, 3, v32
    v_mul_u32_u24 v32, 320, v32
    v_lshl_add_u32 v13, v34, 3, v32
    v_add_u32 v13, s29, v13
    s_barrier
    s_barrier
    s_barrier
    s_barrier
    s_cmp_ge_u32 s38, 136
    s_cbranch_scc1 L_p_norl3
    s_mul_i32 s30, s39, 136
    s_add_u32 s30, s30, s38
    s_mul_i32 s30, s30, 5120
    s_add_u32 s30, s30, 11534336
    s_add_u32 s31, s30, 4096
    s_waitcnt vmcnt(0)
    ds_read_b64_tr_b16 v[48:49], v13 offset:0
    ds_read_b64_tr_b16 v[50:51], v13 offset:1280
    ds_read_b64_tr_b16 v[52:53], v13 offset:64
    ds_read_b64_tr_b16 v[54:55], v13 offset:1344
    ds_read_b64_tr_b16 v[56:57], v13 offset:128
    ds_read_b64_tr_b16 v[58:59], v13 offset:1408
    ds_read_b64_tr_b16 v[60:61], v13 offset:192
    ds_read_b64_tr_b16 v[62:63], v13 offset:1472
    ds_read_b64_tr_b16 v[64:65], v13 offset:256
    ds_read_b64_tr_b16 v[66:67], v13 offset:1536
    s_waitcnt lgkmcnt(8)
    buffer_store_dwordx4 v[48:51], v30, s[8:11], s30 offen offset:0 sc1
    s_waitcnt lgkmcnt(6)
    buffer_store_dwordx4 v[52:55], v30, s[8:11], s30 offen offset:1024 sc1
    s_waitcnt lgkmcnt(4)
    buffer_store_dwordx4 v[56:59], v30, s[8:11], s30 offen offset:2048 sc1
    s_waitcnt lgkmcnt(2)
    buffer_store_dwordx4 v[60:63], v30, s[8:11], s30 offen offset:3072 sc1
    s_waitcnt lgkmcnt(0)
    buffer_store_dwordx4 v[64:67], v30, s[8:11], s31 offen sc1
L_p_norl3:
    s_barrier
    s_mov_b32 s67, 0
    s_setprio 0
    s_branch L_a_start
L_p_cwave:
    v_and_b32 v2, 31, v1
    v_lshrrev_b32 v3, 5, v1
    v_bfe_u32 v40, v1, 1, 3
    v_xor_b32 v40, v40, v3
    s_lshl_b32 s30, s6, 12
    s_add_u32 s30, s30, 73728
    v_lshlrev_b32 v41, 7, v2
    v_add_u32 v41, s30, v41
    v_xor_b32 v42, 0, v40
    v_lshl_add_u32 v4, v42, 4, v41
    v_xor_b32 v42, 2, v40
    v_lshl_add_u32 v5, v42, 4, v41
    v_xor_b32 v42, 4, v40
    v_lshl_add_u32 v6, v42, 4, v41
    v_xor_b32 v42, 6, v40
    v_lshl_add_u32 v7, v42, 4, v41
    v_bfe_u32 v40, v1, 2, 2
    v_lshl_add_u32 v40, v3, 3, v40
    v_mul_u32_u24 v40, 320, v40
    v_add_u32 v40, 90112, v40
    v_bfe_u32 v41, v1, 4, 1
    v_and_b32 v42, 3, v1
    v_lshl_add_u32 v41, v41, 2, v42
    v_or_b32 v41, 0x0c0c0c00, v41
    v_lshrrev_b32 v43, 2, v2
    v_or_b32 v43, 0x0c0c0c00, v43
    v_lshlrev_b32 v44, 3, v42
    s_mul_i32 s32, s23, 1280
    s_add_u32 s32, s32, 14594048
    v_add_u32 v44, s32, v44
    s_mov_b32 s30, 0x3020100
    s_mov_b32 s31, 0x7060504
    s_cmp_lt_u32 s23, 4
    s_cselect_b32 s30, 0x3010200, s30
    s_cselect_b32 s31, 0x8060705, s31
    v_mov_b32 v45, s30
    v_perm_b32 v46, s31, v45, v41
    v_lshl_add_u32 v8, v46, 3, v40
    v_perm_b32 v46, s31, v45, v43
    v_lshl_add_u32 v31, v46, 5, v44
    s_mov_b32 s30, 0xb0a0908
    s_mov_b32 s31, 0xf0e0d0c
    s_cmp_lt_u32 s23, 4
    s_cselect_b32 s30, 0xd0b0c0a, s30
    s_cselect_b32 s31, 0x1210110f, s31
    v_mov_b32 v45, s30
    v_perm_b32 v46, s31, v45, v41
    v_lshl_add_u32 v9, v46, 3, v40
    v_perm_b32 v46, s31, v45, v43
    v_lshl_add_u32 v32, v46, 5, v44
    s_mov_b32 s30, 0x13121110
    s_mov_b32 s31, 0x17161514
    s_cmp_lt_u32 s23, 4
    s_cselect_b32 s30, 0x17151614, s30
    s_cselect_b32 s31, 0x1c1a1b19, s31
    v_mov_b32 v45, s30
    v_perm_b32 v46, s31, v45, v41
    v_lshl_add_u32 v10, v46, 3, v40
    v_perm_b32 v46, s31, v45, v43
    v_lshl_add_u32 v33, v46, 5, v44
    s_mov_b32 s30, 0x1b1a1918
    s_mov_b32 s31, 0x1f1e1d1c
    s_cmp_lt_u32 s23, 4
    s_cselect_b32 s30, 0x211f201e, s30
    s_cselect_b32 s31, 0x26242523, s31
    v_mov_b32 v45, s30
    v_perm_b32 v46, s31, v45, v41
    v_lshl_add_u32 v11, v46, 3, v40
    v_perm_b32 v46, s31, v45, v43
    v_lshl_add_u32 v34, v46, 5, v44
    s_mov_b32 s30, 0x23222120
    s_mov_b32 s31, 0x27262524
    s_cmp_lt_u32 s23, 4
    s_cselect_b32 s30, 0x1d091804, s30
    s_cselect_b32 s31, 0x2713220e, s31
    v_mov_b32 v45, s30
    v_perm_b32 v46, s31, v45, v41
    v_lshl_add_u32 v12, v46, 3, v40
    v_perm_b32 v46, s31, v45, v43
    v_lshl_add_u32 v35, v46, 5, v44
    v_mov_b32 v88, 0
    v_mov_b32 v89, 0
    v_mov_b32 v90, 0
    v_mov_b32 v91, 0
    v_mov_b32 v92, 0
    v_mov_b32 v93, 0
    v_mov_b32 v94, 0
    v_mov_b32 v95, 0
    v_mov_b32 v96, 0
    v_mov_b32 v97, 0
    v_mov_b32 v98, 0
    v_mov_b32 v99, 0
    v_mov_b32 v100, 0
    v_mov_b32 v101, 0
    v_mov_b32 v102, 0
    v_mov_b32 v103, 0
    v_mov_b32 v104, 0
    v_mov_b32 v105, 0
    v_mov_b32 v106, 0
    v_mov_b32 v107, 0
    v_mov_b32 v108, 0
    v_mov_b32 v109, 0
    v_mov_b32 v110, 0
    v_mov_b32 v111, 0
    v_mov_b32 v112, 0
    v_mov_b32 v113, 0
    v_mov_b32 v114, 0
    v_mov_b32 v115, 0
    v_mov_b32 v116, 0
    v_mov_b32 v117, 0
    v_mov_b32 v118, 0
    v_mov_b32 v119, 0
    v_mov_b32 v120, 0
    v_mov_b32 v121, 0
    v_mov_b32 v122, 0
    v_mov_b32 v123, 0
    v_mov_b32 v124, 0
    v_mov_b32 v125, 0
    v_mov_b32 v126, 0
    v_mov_b32 v127, 0
    v_mov_b32 v128, 0
    v_mov_b32 v129, 0
    v_mov_b32 v130, 0
    v_mov_b32 v131, 0
    v_mov_b32 v132, 0
    v_mov_b32 v133, 0
    v_mov_b32 v134, 0
    v_mov_b32 v135, 0
    v_mov_b32 v136, 0
    v_mov_b32 v137, 0
    v_mov_b32 v138, 0
    v_mov_b32 v139, 0
    v_mov_b32 v140, 0
    v_mov_b32 v141, 0
    v_mov_b32 v142, 0
    v_mov_b32 v143, 0
    v_mov_b32 v144, 0
    v_mov_b32 v145, 0
    v_mov_b32 v146, 0
    v_mov_b32 v147, 0
    v_mov_b32 v148, 0
    v_mov_b32 v149, 0
    v_mov_b32 v150, 0
    v_mov_b32 v151, 0
    v_mov_b32 v152, 0
    v_mov_b32 v153, 0
    v_mov_b32 v154, 0
    v_mov_b32 v155, 0
    v_mov_b32 v156, 0
    v_mov_b32 v157, 0
    v_mov_b32 v158, 0
    v_mov_b32 v159, 0
    v_mov_b32 v160, 0
    v_mov_b32 v161, 0
    v_mov_b32 v162, 0
    v_mov_b32 v163, 0
    v_mov_b32 v164, 0
    v_mov_b32 v165, 0
    v_mov_b32 v166, 0
    v_mov_b32 v167, 0
    v_lshlrev_b32 v13, 4, v2
    s_lshl_b32 s36, s29, 9
    s_add_u32 s36, s36, 14630912
    s_mov_b32 s33, 0
    s_mov_b32 s34, 73728
    s_mul_i32 s37, s29, 4224
    s_and_b32 s31, s23, 3
    s_lshl_b32 s31, s31, 3
    s_add_u32 s37, s37, s31
    s_add_u32 s37, s37, 14781440
    s_cmp_eq_u32 s23, 13
    s_cbranch_scc0 L_p_full
    v_mov_b32 v34, v31
    v_mov_b32 v35, v31
L_p_full:
    s_waitcnt lgkmcnt(0)
    s_mov_b32 s8, s4
    s_mov_b32 s9, s5
    s_mov_b32 s10, 15204352
    s_mov_b32 s11, 0x00020000
    s_mov_b32 s16, s62
    s_mov_b32 s17, s63
    s_mov_b32 s18, 256
    s_mov_b32 s19, 0x00020000
    s_barrier
    s_waitcnt lgkmcnt(0)
    ds_read_b128 v[14:17], v4
    ds_read_b64_tr_b16 v[44:45], v8 offset:0
    ds_read_b64_tr_b16 v[46:47], v8 offset:1280
    ds_read_b64_tr_b16 v[48:49], v9 offset:0
    ds_read_b64_tr_b16 v[50:51], v9 offset:1280
    ds_read_b64_tr_b16 v[52:53], v10 offset:0
    ds_read_b64_tr_b16 v[54:55], v10 offset:1280
    ds_read_b64_tr_b16 v[56:57], v11 offset:0
    ds_read_b64_tr_b16 v[58:59], v11 offset:1280
    ds_read_b64_tr_b16 v[60:61], v12 offset:0
    ds_read_b64_tr_b16 v[62:63], v12 offset:1280
.p2align 6
L_p_loop:
    s_waitcnt lgkmcnt(8)
    v_mfma_f32_32x32x16_bf16 v[88:103], v[44:47], v[14:17], v[88:103]
    ds_read_b128 v[18:21], v5
    ds_read_b64_tr_b16 v[64:65], v8 offset:5120
    ds_read_b64_tr_b16 v[66:67], v8 offset:6400
    s_waitcnt lgkmcnt(9)
    v_mfma_f32_32x32x16_bf16 v[104:119], v[48:51], v[14:17], v[104:119]
    ds_read_b64_tr_b16 v[68:69], v9 offset:5120
    ds_read_b64_tr_b16 v[70:71], v9 offset:6400
    s_waitcnt lgkmcnt(9)
    v_mfma_f32_32x32x16_bf16 v[120:135], v[52:55], v[14:17], v[120:135]
    ds_read_b64_tr_b16 v[72:73], v10 offset:5120
    ds_read_b64_tr_b16 v[74:75], v10 offset:6400
    s_waitcnt lgkmcnt(9)
    v_mfma_f32_32x32x16_bf16 v[136:151], v[56:59], v[14:17], v[136:151]
    ds_read_b64_tr_b16 v[76:77], v11 offset:5120
    ds_read_b64_tr_b16 v[78:79], v11 offset:6400
    s_waitcnt lgkmcnt(9)
    v_mfma_f32_32x32x16_bf16 v[152:167], v[60:63], v[14:17], v[152:167]
    ds_read_b64_tr_b16 v[80:81], v12 offset:5120
    ds_read_b64_tr_b16 v[82:83], v12 offset:6400
    s_cmp_lg_u32 s33, 9
    s_cbranch_scc1 L_p_nost
    buffer_load_dwordx2 v[0:1], off, s[8:11], s37 offset:64 sc1
    buffer_load_dword v30, off, s[16:19], 0 sc1
    buffer_load_dwordx4 v[36:39], v13, s[8:11], s36 offen sc1
    buffer_load_dwordx2 v[84:85], v31, s[8:11], 0 offen sc1
    buffer_load_dwordx2 v[86:87], v32, s[8:11], 0 offen sc1
    buffer_load_dwordx2 v[40:41], v33, s[8:11], 0 offen sc1
    buffer_load_dwordx2 v[42:43], v34, s[8:11], 0 offen sc1
    buffer_load_dwordx2 v[2:3], v35, s[8:11], 0 offen sc1
L_p_nost:
    s_waitcnt lgkmcnt(8)
    v_mfma_f32_32x32x16_bf16 v[88:103], v[64:67], v[18:21], v[88:103]
    ds_read_b128 v[22:25], v6
    ds_read_b64_tr_b16 v[44:45], v8 offset:10240
    ds_read_b64_tr_b16 v[46:47], v8 offset:11520
    s_waitcnt lgkmcnt(9)
    v_mfma_f32_32x32x16_bf16 v[104:119], v[68:71], v[18:21], v[104:119]
    ds_read_b64_tr_b16 v[48:49], v9 offset:10240
    ds_read_b64_tr_b16 v[50:51], v9 offset:11520
    s_waitcnt lgkmcnt(9)
    v_mfma_f32_32x32x16_bf16 v[120:135], v[72:75], v[18:21], v[120:135]
    ds_read_b64_tr_b16 v[52:53], v10 offset:10240
    ds_read_b64_tr_b16 v[54:55], v10 offset:11520
    s_waitcnt lgkmcnt(9)
    v_mfma_f32_32x32x16_bf16 v[136:151], v[76:79], v[18:21], v[136:151]
    ds_read_b64_tr_b16 v[56:57], v11 offset:10240
    ds_read_b64_tr_b16 v[58:59], v11 offset:11520
    s_waitcnt lgkmcnt(9)
    v_mfma_f32_32x32x16_bf16 v[152:167], v[80:83], v[18:21], v[152:167]
    ds_read_b64_tr_b16 v[60:61], v12 offset:10240
    ds_read_b64_tr_b16 v[62:63], v12 offset:11520
    s_waitcnt lgkmcnt(8)
    v_mfma_f32_32x32x16_bf16 v[88:103], v[44:47], v[22:25], v[88:103]
    ds_read_b128 v[26:29], v7
    ds_read_b64_tr_b16 v[64:65], v8 offset:15360
    ds_read_b64_tr_b16 v[66:67], v8 offset:16640
    s_waitcnt lgkmcnt(9)
    v_mfma_f32_32x32x16_bf16 v[104:119], v[48:51], v[22:25], v[104:119]
    ds_read_b64_tr_b16 v[68:69], v9 offset:15360
    ds_read_b64_tr_b16 v[70:71], v9 offset:16640
    s_waitcnt lgkmcnt(9)
    v_mfma_f32_32x32x16_bf16 v[120:135], v[52:55], v[22:25], v[120:135]
    ds_read_b64_tr_b16 v[72:73], v10 offset:15360
    ds_read_b64_tr_b16 v[74:75], v10 offset:16640
    s_waitcnt lgkmcnt(9)
    v_mfma_f32_32x32x16_bf16 v[136:151], v[56:59], v[22:25], v[136:151]
    ds_read_b64_tr_b16 v[76:77], v11 offset:15360
    ds_read_b64_tr_b16 v[78:79], v11 offset:16640
    s_waitcnt lgkmcnt(9)
    v_mfma_f32_32x32x16_bf16 v[152:167], v[60:63], v[22:25], v[152:167]
    ds_read_b64_tr_b16 v[80:81], v12 offset:15360
    ds_read_b64_tr_b16 v[82:83], v12 offset:16640
    s_add_u32 s34, s34, 36864
    s_cmp_ge_u32 s34, 147456
    s_mov_b32 s35, 36864
    s_cselect_b32 s35, 0xfffe5000, s35
    s_cselect_b32 s34, 0, s34
    v_add_u32 v4, s35, v4
    v_add_u32 v5, s35, v5
    v_add_u32 v6, s35, v6
    v_add_u32 v7, s35, v7
    v_add_u32 v8, s35, v8
    v_add_u32 v9, s35, v9
    v_add_u32 v10, s35, v10
    v_add_u32 v11, s35, v11
    v_add_u32 v12, s35, v12
    s_cmp_eq_u32 s33, 9
    s_cbranch_scc1 L_p_last
    s_barrier
    s_waitcnt lgkmcnt(8)
    v_mfma_f32_32x32x16_bf16 v[88:103], v[64:67], v[26:29], v[88:103]
    ds_read_b128 v[14:17], v4
    ds_read_b64_tr_b16 v[44:45], v8 offset:0
    ds_read_b64_tr_b16 v[46:47], v8 offset:1280
    s_waitcnt lgkmcnt(9)
    v_mfma_f32_32x32x16_bf16 v[104:119], v[68:71], v[26:29], v[104:119]
    ds_read_b64_tr_b16 v[48:49], v9 offset:0
    ds_read_b64_tr_b16 v[50:51], v9 offset:1280
    s_waitcnt lgkmcnt(9)
    v_mfma_f32_32x32x16_bf16 v[120:135], v[72:75], v[26:29], v[120:135]
    ds_read_b64_tr_b16 v[52:53], v10 offset:0
    ds_read_b64_tr_b16 v[54:55], v10 offset:1280
    s_waitcnt lgkmcnt(9)
    v_mfma_f32_32x32x16_bf16 v[136:151], v[76:79], v[26:29], v[136:151]
    ds_read_b64_tr_b16 v[56:57], v11 offset:0
    ds_read_b64_tr_b16 v[58:59], v11 offset:1280
    s_waitcnt lgkmcnt(9)
    v_mfma_f32_32x32x16_bf16 v[152:167], v[80:83], v[26:29], v[152:167]
    ds_read_b64_tr_b16 v[60:61], v12 offset:0
    ds_read_b64_tr_b16 v[62:63], v12 offset:1280
    s_add_u32 s33, s33, 1
    s_branch L_p_loop
L_p_last:
    v_mov_b32 v44, 163584
    v_mov_b32 v45, 1
    s_waitcnt lgkmcnt(0)
    s_mov_b64 exec, 1
    ds_add_u32 v44, v45 offset:48
    s_mov_b64 exec, -1
    v_mfma_f32_32x32x16_bf16 v[88:103], v[64:67], v[26:29], v[88:103]
    v_mfma_f32_32x32x16_bf16 v[104:119], v[68:71], v[26:29], v[104:119]
    v_mfma_f32_32x32x16_bf16 v[120:135], v[72:75], v[26:29], v[120:135]
    v_mfma_f32_32x32x16_bf16 v[136:151], v[76:79], v[26:29], v[136:151]
    v_mfma_f32_32x32x16_bf16 v[152:167], v[80:83], v[26:29], v[152:167]
    s_setprio 3
    s_mov_b32 s28, 0
L_p_stchk:
    s_waitcnt vmcnt(0)
    v_readfirstlane_b32 s64, v30
    v_min_u32 v48, v39, v85
    v_max_u32 v49, v39, v85
    v_min3_u32 v48, v48, v87, v41
    v_max3_u32 v49, v49, v87, v41
    v_min3_u32 v48, v48, v43, v3
    v_max3_u32 v49, v49, v43, v3
    v_cmp_ne_u32 vcc, s64, v48
    v_cmp_ne_u32 s[30:31], s64, v49
    s_or_b64 vcc, vcc, s[30:31]
    s_cmp_eq_u32 s64, 0
    s_cselect_b32 vcc_lo, -1, vcc_lo
    s_cmp_eq_u64 vcc, 0
    s_cbranch_scc1 L_p_havest
    s_add_u32 s28, s28, 1
    s_cmp_ge_u32 s28, 131072
    s_cbranch_scc1 L_p_havest
    s_sleep 2
    buffer_load_dword v30, off, s[16:19], 0 sc1
    buffer_load_dwordx4 v[36:39], v13, s[8:11], s36 offen sc1
    buffer_load_dwordx2 v[84:85], v31, s[8:11], 0 offen sc1
    buffer_load_dwordx2 v[86:87], v32, s[8:11], 0 offen sc1
    buffer_load_dwordx2 v[40:41], v33, s[8:11], 0 offen sc1
    buffer_load_dwordx2 v[42:43], v34, s[8:11], 0 offen sc1
    buffer_load_dwordx2 v[2:3], v35, s[8:11], 0 offen sc1
    s_branch L_p_stchk
L_p_havest:
    v_readfirstlane_b32 s32, v0
    v_readfirstlane_b32 s33, v1
    v_mbcnt_lo_u32_b32 v1, -1, 0
    v_mbcnt_hi_u32_b32 v1, -1, v1
    v_lshlrev_b32 v30, 4, v1
    v_mov_b32 v39, 0
    s_mov_b32 exec_lo, 0
    v_mov_b32 v38, 0
    s_mov_b64 exec, -1
    v_mov_b32 v85, 0
    v_mov_b32 v87, 0
    v_mov_b32 v41, 0
    v_mov_b32 v43, 0
    v_mov_b32 v3, 0
    s_nop 1
    v_mfma_f32_32x32x8_bf16 v[88:103], v[84:85], v[38:39], v[88:103]
    v_mfma_f32_32x32x8_bf16 v[104:119], v[86:87], v[38:39], v[104:119]
    s_cmp_ge_u32 s23, 4
    s_cbranch_scc1 L_p_epi_h
    s_lshl_b32 s30, s29, 2
    s_add_u32 s30, s30, s23
    s_mul_i32 s30, s30, 10240
    s_add_u32 s30, s30, 0
    v_mul_f32 v14, 0x3ea52b5c, v36
    s_xor_b32 s32, s32, s64
    s_xor_b32 s33, s33, s54
    s_or_b32 s55, s32, s33
    s_mul_i32 s34, s29, 4224
    s_lshl_b32 s31, s23, 7
    s_add_u32 s34, s34, s31
    s_add_u32 s34, s34, 14781568
    v_mfma_f32_32x32x8_bf16 v[120:135], v[40:41], v[38:39], v[120:135]
    v_mul_f32 v88, v88, v14
    v_mul_f32 v89, v89, v14
    v_mul_f32 v90, v90, v14
    v_mul_f32 v91, v91, v14
    v_mul_f32 v92, v92, v14
    v_mul_f32 v93, v93, v14
    v_mul_f32 v94, v94, v14
    v_mul_f32 v95, v95, v14
    v_mul_f32 v96, v96, v14
    v_mul_f32 v97, v97, v14
    v_mul_f32 v98, v98, v14
    v_mul_f32 v99, v99, v14
    v_mul_f32 v100, v100, v14
    v_mul_f32 v101, v101, v14
    v_mul_f32 v102, v102, v14
    v_mul_f32 v103, v103, v14
    v_cvt_pk_bf16_f32 v44, v88, v89
    v_cvt_pk_bf16_f32 v45, v90, v91
    v_cvt_pk_bf16_f32 v46, v92, v93
    v_cvt_pk_bf16_f32 v47, v94, v95
    v_cvt_pk_bf16_f32 v48, v96, v97
    v_cvt_pk_bf16_f32 v49, v98, v99
    v_cvt_pk_bf16_f32 v50, v100, v101
    v_cvt_pk_bf16_f32 v51, v102, v103
    s_cmp_eq_u32 s55, 0
    s_cbranch_scc1 L_p_qs0_l
    buffer_store_dwordx4 v[44:47], v30, s[8:11], s30 offen sc1
    buffer_store_dwordx4 v[48:51], v30, s[8:11], s30 offen offset:1024 sc1
    s_branch L_p_qs0_e
L_p_qs0_l:
    buffer_store_dwordx4 v[44:47], v30, s[8:11], s30 offen
    buffer_store_dwordx4 v[48:51], v30, s[8:11], s30 offen offset:1024
L_p_qs0_e:
    s_add_u32 s30, s30, 2048
    v_mfma_f32_32x32x8_bf16 v[136:151], v[42:43], v[38:39], v[136:151]
    v_mul_f32 v104, v104, v14
    v_mul_f32 v105, v105, v14
    v_mul_f32 v106, v106, v14
    v_mul_f32 v107, v107, v14
    v_mul_f32 v108, v108, v14
    v_mul_f32 v109, v109, v14
    v_mul_f32 v110, v110, v14
    v_mul_f32 v111, v111, v14
    v_mul_f32 v112, v112, v14
    v_mul_f32 v113, v113, v14
    v_mul_f32 v114, v114, v14
    v_mul_f32 v115, v115, v14
    v_mul_f32 v116, v116, v14
    v_mul_f32 v117, v117, v14
    v_mul_f32 v118, v118, v14
    v_mul_f32 v119, v119, v14
    v_cvt_pk_bf16_f32 v52, v104, v105
    v_cvt_pk_bf16_f32 v53, v106, v107
    v_cvt_pk_bf16_f32 v54, v108, v109
    v_cvt_pk_bf16_f32 v55, v110, v111
    v_cvt_pk_bf16_f32 v56, v112, v113
    v_cvt_pk_bf16_f32 v57, v114, v115
    v_cvt_pk_bf16_f32 v58, v116, v117
    v_cvt_pk_bf16_f32 v59, v118, v119
    s_cmp_eq_u32 s55, 0
    s_cbranch_scc1 L_p_qs1_l
    buffer_store_dwordx4 v[52:55], v30, s[8:11], s30 offen sc1
    buffer_store_dwordx4 v[56:59], v30, s[8:11], s30 offen offset:1024 sc1
    s_branch L_p_qs1_e
L_p_qs1_l:
    buffer_store_dwordx4 v[52:55], v30, s[8:11], s30 offen
    buffer_store_dwordx4 v[56:59], v30, s[8:11], s30 offen offset:1024
L_p_qs1_e:
    s_add_u32 s30, s30, 2048
    v_mfma_f32_32x32x8_bf16 v[152:167], v[2:3], v[38:39], v[152:167]
    v_mul_f32 v120, v120, v14
    v_mul_f32 v121, v121, v14
    v_mul_f32 v122, v122, v14
    v_mul_f32 v123, v123, v14
    v_mul_f32 v124, v124, v14
    v_mul_f32 v125, v125, v14
    v_mul_f32 v126, v126, v14
    v_mul_f32 v127, v127, v14
    v_mul_f32 v128, v128, v14
    v_mul_f32 v129, v129, v14
    v_mul_f32 v130, v130, v14
    v_mul_f32 v131, v131, v14
    v_mul_f32 v132, v132, v14
    v_mul_f32 v133, v133, v14
    v_mul_f32 v134, v134, v14
    v_mul_f32 v135, v135, v14
    v_cvt_pk_bf16_f32 v60, v120, v121
    v_cvt_pk_bf16_f32 v61, v122, v123
    v_cvt_pk_bf16_f32 v62, v124, v125
    v_cvt_pk_bf16_f32 v63, v126, v127
    v_cvt_pk_bf16_f32 v64, v128, v129
    v_cvt_pk_bf16_f32 v65, v130, v131
    v_cvt_pk_bf16_f32 v66, v132, v133
    v_cvt_pk_bf16_f32 v67, v134, v135
    s_cmp_eq_u32 s55, 0
    s_cbranch_scc1 L_p_qs2_l
    buffer_store_dwordx4 v[60:63], v30, s[8:11], s30 offen sc1
    buffer_store_dwordx4 v[64:67], v30, s[8:11], s30 offen offset:1024 sc1
    s_branch L_p_qs2_e
L_p_qs2_l:
    buffer_store_dwordx4 v[60:63], v30, s[8:11], s30 offen
    buffer_store_dwordx4 v[64:67], v30, s[8:11], s30 offen offset:1024
L_p_qs2_e:
    s_add_u32 s30, s30, 2048
    v_mul_f32 v136, v136, v14
    v_mul_f32 v137, v137, v14
    v_mul_f32 v138, v138, v14
    v_mul_f32 v139, v139, v14
    v_mul_f32 v140, v140, v14
    v_mul_f32 v141, v141, v14
    v_mul_f32 v142, v142, v14
    v_mul_f32 v143, v143, v14
    v_mul_f32 v144, v144, v14
    v_mul_f32 v145, v145, v14
    v_mul_f32 v146, v146, v14
    v_mul_f32 v147, v147, v14
    v_mul_f32 v148, v148, v14
    v_mul_f32 v149, v149, v14
    v_mul_f32 v150, v150, v14
    v_mul_f32 v151, v151, v14
    v_cvt_pk_bf16_f32 v68, v136, v137
    v_cvt_pk_bf16_f32 v69, v138, v139
    v_cvt_pk_bf16_f32 v70, v140, v141
    v_cvt_pk_bf16_f32 v71, v142, v143
    v_cvt_pk_bf16_f32 v72, v144, v145
    v_cvt_pk_bf16_f32 v73, v146, v147
    v_cvt_pk_bf16_f32 v74, v148, v149
    v_cvt_pk_bf16_f32 v75, v150, v151
    s_cmp_eq_u32 s55, 0
    s_cbranch_scc1 L_p_qs3_l
    buffer_store_dwordx4 v[68:71], v30, s[8:11], s30 offen sc1
    buffer_store_dwordx4 v[72:75], v30, s[8:11], s30 offen offset:1024 sc1
    s_branch L_p_qs3_e
L_p_qs3_l:
    buffer_store_dwordx4 v[68:71], v30, s[8:11], s30 offen
    buffer_store_dwordx4 v[72:75], v30, s[8:11], s30 offen offset:1024
L_p_qs3_e:
    s_add_u32 s30, s30, 2048
    v_mul_f32 v152, v152, v14
    v_mul_f32 v153, v153, v14
    v_mul_f32 v154, v154, v14
    v_mul_f32 v155, v155, v14
    v_mul_f32 v156, v156, v14
    v_mul_f32 v157, v157, v14
    v_mul_f32 v158, v158, v14
    v_mul_f32 v159, v159, v14
    v_mul_f32 v160, v160, v14
    v_mul_f32 v161, v161, v14
    v_mul_f32 v162, v162, v14
    v_mul_f32 v163, v163, v14
    v_mul_f32 v164, v164, v14
    v_mul_f32 v165, v165, v14
    v_mul_f32 v166, v166, v14
    v_mul_f32 v167, v167, v14
    v_cvt_pk_bf16_f32 v76, v152, v153
    v_cvt_pk_bf16_f32 v77, v154, v155
    v_cvt_pk_bf16_f32 v78, v156, v157
    v_cvt_pk_bf16_f32 v79, v158, v159
    v_cvt_pk_bf16_f32 v80, v160, v161
    v_cvt_pk_bf16_f32 v81, v162, v163
    v_cvt_pk_bf16_f32 v82, v164, v165
    v_cvt_pk_bf16_f32 v83, v166, v167
    s_cmp_eq_u32 s55, 0
    s_cbranch_scc1 L_p_qs4_l
    buffer_store_dwordx4 v[76:79], v30, s[8:11], s30 offen sc1
    buffer_store_dwordx4 v[80:83], v30, s[8:11], s30 offen offset:1024 sc1
    s_branch L_p_qs4_e
L_p_qs4_l:
    buffer_store_dwordx4 v[76:79], v30, s[8:11], s30 offen
    buffer_store_dwordx4 v[80:83], v30, s[8:11], s30 offen offset:1024
L_p_qs4_e:
    s_add_u32 s30, s30, 2048
    v_mov_b32 v42, 163584
    v_mov_b32 v43, 1
    s_mov_b64 exec, 1
    ds_add_u32 v42, v43 offset:52
    s_mov_b64 exec, -1
    v_mov_b32 v40, s64
    s_mov_b64 exec, 1
    s_waitcnt vmcnt(0)
    s_cmp_eq_u32 s55, 0
    s_cbranch_scc1 L_p_qf_l
    buffer_store_dword v40, off, s[8:11], s34 sc1
    s_branch L_p_qf_e
L_p_qf_l:
    buffer_store_dword v40, off, s[8:11], s34
L_p_qf_e:
    s_mov_b64 exec, -1
    s_mov_b32 s67, 0
    s_branch L_a_start
L_p_epi_h:
    v_mfma_f32_32x32x8_bf16 v[152:167], v[2:3], v[38:39], v[152:167]
    v_mfma_f32_32x32x8_bf16 v[136:151], v[42:43], v[38:39], v[136:151]
    v_mfma_f32_32x32x8_bf16 v[120:135], v[40:41], v[38:39], v[120:135]
    s_mul_i32 s30, s29, 136
    s_sub_u32 s31, s23, 4
    s_mul_i32 s31, s31, 10
    s_add_u32 s30, s30, s31
    s_add_u32 s30, s30, 40
    s_lshl_b32 s30, s30, 10
    s_add_u32 s65, s30, 2621440
    s_mov_b32 s67, 1
    s_mov_b32 s69, s23
    v_mul_f32 v40, 0xbfb8aa3b, v36
    v_mov_b32 v41, v40
    v_mov_b32 v42, v37
    v_mov_b32 v43, v37
    s_nop 1
    s_cmp_eq_u32 s23, 13
    s_cbranch_scc1 L_p_h2
    v_pk_mul_f32 v[64:65], v[152:153], v[40:41]
    v_pk_mul_f32 v[66:67], v[154:155], v[40:41]
    v_pk_mul_f32 v[68:69], v[156:157], v[40:41]
    v_pk_mul_f32 v[70:71], v[158:159], v[40:41]
    v_pk_mul_f32 v[72:73], v[160:161], v[40:41]
    v_pk_mul_f32 v[74:75], v[162:163], v[40:41]
    v_pk_mul_f32 v[76:77], v[164:165], v[40:41]
    v_pk_mul_f32 v[78:79], v[166:167], v[40:41]
    v_exp_f32 v64, v64
    v_exp_f32 v65, v65
    v_exp_f32 v66, v66
    v_exp_f32 v67, v67
    v_exp_f32 v68, v68
    v_exp_f32 v69, v69
    v_exp_f32 v70, v70
    v_exp_f32 v71, v71
    v_exp_f32 v72, v72
    v_exp_f32 v73, v73
    v_exp_f32 v74, v74
    v_exp_f32 v75, v75
    v_exp_f32 v76, v76
    v_exp_f32 v77, v77
    v_exp_f32 v78, v78
    v_exp_f32 v79, v79
    v_pk_fma_f32 v[64:65], v[64:65], v[42:43], v[42:43]
    v_pk_fma_f32 v[66:67], v[66:67], v[42:43], v[42:43]
    v_pk_fma_f32 v[68:69], v[68:69], v[42:43], v[42:43]
    v_pk_fma_f32 v[70:71], v[70:71], v[42:43], v[42:43]
    v_pk_fma_f32 v[72:73], v[72:73], v[42:43], v[42:43]
    v_pk_fma_f32 v[74:75], v[74:75], v[42:43], v[42:43]
    v_pk_fma_f32 v[76:77], v[76:77], v[42:43], v[42:43]
    v_pk_fma_f32 v[78:79], v[78:79], v[42:43], v[42:43]
    v_rcp_f32 v64, v64
    v_rcp_f32 v65, v65
    v_rcp_f32 v66, v66
    v_rcp_f32 v67, v67
    v_rcp_f32 v68, v68
    v_rcp_f32 v69, v69
    v_rcp_f32 v70, v70
    v_rcp_f32 v71, v71
    v_rcp_f32 v72, v72
    v_rcp_f32 v73, v73
    v_rcp_f32 v74, v74
    v_rcp_f32 v75, v75
    v_rcp_f32 v76, v76
    v_rcp_f32 v77, v77
    v_rcp_f32 v78, v78
    v_rcp_f32 v79, v79
    v_pk_mul_f32 v[64:65], v[64:65], v[152:153]
    v_pk_mul_f32 v[66:67], v[66:67], v[154:155]
    v_pk_mul_f32 v[68:69], v[68:69], v[156:157]
    v_pk_mul_f32 v[70:71], v[70:71], v[158:159]
    v_pk_mul_f32 v[72:73], v[72:73], v[160:161]
    v_pk_mul_f32 v[74:75], v[74:75], v[162:163]
    v_pk_mul_f32 v[76:77], v[76:77], v[164:165]
    v_pk_mul_f32 v[78:79], v[78:79], v[166:167]
    v_cvt_pk_bf16_f32 v160, v64, v65
    v_cvt_pk_bf16_f32 v161, v66, v67
    v_cvt_pk_bf16_f32 v162, v68, v69
    v_cvt_pk_bf16_f32 v163, v70, v71
    v_cvt_pk_bf16_f32 v164, v72, v73
    v_cvt_pk_bf16_f32 v165, v74, v75
    v_cvt_pk_bf16_f32 v166, v76, v77
    v_cvt_pk_bf16_f32 v167, v78, v79
    v_pk_mul_f32 v[64:65], v[136:137], v[40:41]
    v_pk_mul_f32 v[66:67], v[138:139], v[40:41]
    v_pk_mul_f32 v[68:69], v[140:141], v[40:41]
    v_pk_mul_f32 v[70:71], v[142:143], v[40:41]
    v_pk_mul_f32 v[72:73], v[144:145], v[40:41]
    v_pk_mul_f32 v[74:75], v[146:147], v[40:41]
    v_pk_mul_f32 v[76:77], v[148:149], v[40:41]
    v_pk_mul_f32 v[78:79], v[150:151], v[40:41]
    v_exp_f32 v64, v64
    v_exp_f32 v65, v65
    v_exp_f32 v66, v66
    v_exp_f32 v67, v67
    v_exp_f32 v68, v68
    v_exp_f32 v69, v69
    v_exp_f32 v70, v70
    v_exp_f32 v71, v71
    v_exp_f32 v72, v72
    v_exp_f32 v73, v73
    v_exp_f32 v74, v74
    v_exp_f32 v75, v75
    v_exp_f32 v76, v76
    v_exp_f32 v77, v77
    v_exp_f32 v78, v78
    v_exp_f32 v79, v79
    v_pk_fma_f32 v[64:65], v[64:65], v[42:43], v[42:43]
    v_pk_fma_f32 v[66:67], v[66:67], v[42:43], v[42:43]
    v_pk_fma_f32 v[68:69], v[68:69], v[42:43], v[42:43]
    v_pk_fma_f32 v[70:71], v[70:71], v[42:43], v[42:43]
    v_pk_fma_f32 v[72:73], v[72:73], v[42:43], v[42:43]
    v_pk_fma_f32 v[74:75], v[74:75], v[42:43], v[42:43]
    v_pk_fma_f32 v[76:77], v[76:77], v[42:43], v[42:43]
    v_pk_fma_f32 v[78:79], v[78:79], v[42:43], v[42:43]
    v_rcp_f32 v64, v64
    v_rcp_f32 v65, v65
    v_rcp_f32 v66, v66
    v_rcp_f32 v67, v67
    v_rcp_f32 v68, v68
    v_rcp_f32 v69, v69
    v_rcp_f32 v70, v70
    v_rcp_f32 v71, v71
    v_rcp_f32 v72, v72
    v_rcp_f32 v73, v73
    v_rcp_f32 v74, v74
    v_rcp_f32 v75, v75
    v_rcp_f32 v76, v76
    v_rcp_f32 v77, v77
    v_rcp_f32 v78, v78
    v_rcp_f32 v79, v79
    v_pk_mul_f32 v[64:65], v[64:65], v[136:137]
    v_pk_mul_f32 v[66:67], v[66:67], v[138:139]
    v_pk_mul_f32 v[68:69], v[68:69], v[140:141]
    v_pk_mul_f32 v[70:71], v[70:71], v[142:143]
    v_pk_mul_f32 v[72:73], v[72:73], v[144:145]
    v_pk_mul_f32 v[74:75], v[74:75], v[146:147]
    v_pk_mul_f32 v[76:77], v[76:77], v[148:149]
    v_pk_mul_f32 v[78:79], v[78:79], v[150:151]
    v_cvt_pk_bf16_f32 v152, v64, v65
    v_cvt_pk_bf16_f32 v153, v66, v67
    v_cvt_pk_bf16_f32 v154, v68, v69
    v_cvt_pk_bf16_f32 v155, v70, v71
    v_cvt_pk_bf16_f32 v156, v72, v73
    v_cvt_pk_bf16_f32 v157, v74, v75
    v_cvt_pk_bf16_f32 v158, v76, v77
    v_cvt_pk_bf16_f32 v159, v78, v79
L_p_h2:
    v_pk_mul_f32 v[64:65], v[120:121], v[40:41]
    v_pk_mul_f32 v[66:67], v[122:123], v[40:41]
    v_pk_mul_f32 v[68:69], v[124:125], v[40:41]
    v_pk_mul_f32 v[70:71], v[126:127], v[40:41]
    v_pk_mul_f32 v[72:73], v[128:129], v[40:41]
    v_pk_mul_f32 v[74:75], v[130:131], v[40:41]
    v_pk_mul_f32 v[76:77], v[132:133], v[40:41]
    v_pk_mul_f32 v[78:79], v[134:135], v[40:41]
    v_exp_f32 v64, v64
    v_exp_f32 v65, v65
    v_exp_f32 v66, v66
    v_exp_f32 v67, v67
    v_exp_f32 v68, v68
    v_exp_f32 v69, v69
    v_exp_f32 v70, v70
    v_exp_f32 v71, v71
    v_exp_f32 v72, v72
    v_exp_f32 v73, v73
    v_exp_f32 v74, v74
    v_exp_f32 v75, v75
    v_exp_f32 v76, v76
    v_exp_f32 v77, v77
    v_exp_f32 v78, v78
    v_exp_f32 v79, v79
    v_pk_fma_f32 v[64:65], v[64:65], v[42:43], v[42:43]
    v_pk_fma_f32 v[66:67], v[66:67], v[42:43], v[42:43]
    v_pk_fma_f32 v[68:69], v[68:69], v[42:43], v[42:43]
    v_pk_fma_f32 v[70:71], v[70:71], v[42:43], v[42:43]
    v_pk_fma_f32 v[72:73], v[72:73], v[42:43], v[42:43]
    v_pk_fma_f32 v[74:75], v[74:75], v[42:43], v[42:43]
    v_pk_fma_f32 v[76:77], v[76:77], v[42:43], v[42:43]
    v_pk_fma_f32 v[78:79], v[78:79], v[42:43], v[42:43]
    v_rcp_f32 v64, v64
    v_rcp_f32 v65, v65
    v_rcp_f32 v66, v66
    v_rcp_f32 v67, v67
    v_rcp_f32 v68, v68
    v_rcp_f32 v69, v69
    v_rcp_f32 v70, v70
    v_rcp_f32 v71, v71
    v_rcp_f32 v72, v72
    v_rcp_f32 v73, v73
    v_rcp_f32 v74, v74
    v_rcp_f32 v75, v75
    v_rcp_f32 v76, v76
    v_rcp_f32 v77, v77
    v_rcp_f32 v78, v78
    v_rcp_f32 v79, v79
    v_pk_mul_f32 v[64:65], v[64:65], v[120:121]
    v_pk_mul_f32 v[66:67], v[66:67], v[122:123]
    v_pk_mul_f32 v[68:69], v[68:69], v[124:125]
    v_pk_mul_f32 v[70:71], v[70:71], v[126:127]
    v_pk_mul_f32 v[72:73], v[72:73], v[128:129]
    v_pk_mul_f32 v[74:75], v[74:75], v[130:131]
    v_pk_mul_f32 v[76:77], v[76:77], v[132:133]
    v_pk_mul_f32 v[78:79], v[78:79], v[134:135]
    v_cvt_pk_bf16_f32 v144, v64, v65
    v_cvt_pk_bf16_f32 v145, v66, v67
    v_cvt_pk_bf16_f32 v146, v68, v69
    v_cvt_pk_bf16_f32 v147, v70, v71
    v_cvt_pk_bf16_f32 v148, v72, v73
    v_cvt_pk_bf16_f32 v149, v74, v75
    v_cvt_pk_bf16_f32 v150, v76, v77
    v_cvt_pk_bf16_f32 v151, v78, v79
    v_pk_mul_f32 v[64:65], v[104:105], v[40:41]
    v_pk_mul_f32 v[66:67], v[106:107], v[40:41]
    v_pk_mul_f32 v[68:69], v[108:109], v[40:41]
    v_pk_mul_f32 v[70:71], v[110:111], v[40:41]
    v_pk_mul_f32 v[72:73], v[112:113], v[40:41]
    v_pk_mul_f32 v[74:75], v[114:115], v[40:41]
    v_pk_mul_f32 v[76:77], v[116:117], v[40:41]
    v_pk_mul_f32 v[78:79], v[118:119], v[40:41]
    v_exp_f32 v64, v64
    v_exp_f32 v65, v65
    v_exp_f32 v66, v66
    v_exp_f32 v67, v67
    v_exp_f32 v68, v68
    v_exp_f32 v69, v69
    v_exp_f32 v70, v70
    v_exp_f32 v71, v71
    v_exp_f32 v72, v72
    v_exp_f32 v73, v73
    v_exp_f32 v74, v74
    v_exp_f32 v75, v75
    v_exp_f32 v76, v76
    v_exp_f32 v77, v77
    v_exp_f32 v78, v78
    v_exp_f32 v79, v79
    v_pk_fma_f32 v[64:65], v[64:65], v[42:43], v[42:43]
    v_pk_fma_f32 v[66:67], v[66:67], v[42:43], v[42:43]
    v_pk_fma_f32 v[68:69], v[68:69], v[42:43], v[42:43]
    v_pk_fma_f32 v[70:71], v[70:71], v[42:43], v[42:43]
    v_pk_fma_f32 v[72:73], v[72:73], v[42:43], v[42:43]
    v_pk_fma_f32 v[74:75], v[74:75], v[42:43], v[42:43]
    v_pk_fma_f32 v[76:77], v[76:77], v[42:43], v[42:43]
    v_pk_fma_f32 v[78:79], v[78:79], v[42:43], v[42:43]
    v_rcp_f32 v64, v64
    v_rcp_f32 v65, v65
    v_rcp_f32 v66, v66
    v_rcp_f32 v67, v67
    v_rcp_f32 v68, v68
    v_rcp_f32 v69, v69
    v_rcp_f32 v70, v70
    v_rcp_f32 v71, v71
    v_rcp_f32 v72, v72
    v_rcp_f32 v73, v73
    v_rcp_f32 v74, v74
    v_rcp_f32 v75, v75
    v_rcp_f32 v76, v76
    v_rcp_f32 v77, v77
    v_rcp_f32 v78, v78
    v_rcp_f32 v79, v79
    v_pk_mul_f32 v[64:65], v[64:65], v[104:105]
    v_pk_mul_f32 v[66:67], v[66:67], v[106:107]
    v_pk_mul_f32 v[68:69], v[68:69], v[108:109]
    v_pk_mul_f32 v[70:71], v[70:71], v[110:111]
    v_pk_mul_f32 v[72:73], v[72:73], v[112:113]
    v_pk_mul_f32 v[74:75], v[74:75], v[114:115]
    v_pk_mul_f32 v[76:77], v[76:77], v[116:117]
    v_pk_mul_f32 v[78:79], v[78:79], v[118:119]
    v_cvt_pk_bf16_f32 v136, v64, v65
    v_cvt_pk_bf16_f32 v137, v66, v67
    v_cvt_pk_bf16_f32 v138, v68, v69
    v_cvt_pk_bf16_f32 v139, v70, v71
    v_cvt_pk_bf16_f32 v140, v72, v73
    v_cvt_pk_bf16_f32 v141, v74, v75
    v_cvt_pk_bf16_f32 v142, v76, v77
    v_cvt_pk_bf16_f32 v143, v78, v79
    v_pk_mul_f32 v[64:65], v[88:89], v[40:41]
    v_pk_mul_f32 v[66:67], v[90:91], v[40:41]
    v_pk_mul_f32 v[68:69], v[92:93], v[40:41]
    v_pk_mul_f32 v[70:71], v[94:95], v[40:41]
    v_pk_mul_f32 v[72:73], v[96:97], v[40:41]
    v_pk_mul_f32 v[74:75], v[98:99], v[40:41]
    v_pk_mul_f32 v[76:77], v[100:101], v[40:41]
    v_pk_mul_f32 v[78:79], v[102:103], v[40:41]
    v_exp_f32 v64, v64
    v_exp_f32 v65, v65
    v_exp_f32 v66, v66
    v_exp_f32 v67, v67
    v_exp_f32 v68, v68
    v_exp_f32 v69, v69
    v_exp_f32 v70, v70
    v_exp_f32 v71, v71
    v_exp_f32 v72, v72
    v_exp_f32 v73, v73
    v_exp_f32 v74, v74
    v_exp_f32 v75, v75
    v_exp_f32 v76, v76
    v_exp_f32 v77, v77
    v_exp_f32 v78, v78
    v_exp_f32 v79, v79
    v_pk_fma_f32 v[64:65], v[64:65], v[42:43], v[42:43]
    v_pk_fma_f32 v[66:67], v[66:67], v[42:43], v[42:43]
    v_pk_fma_f32 v[68:69], v[68:69], v[42:43], v[42:43]
    v_pk_fma_f32 v[70:71], v[70:71], v[42:43], v[42:43]
    v_pk_fma_f32 v[72:73], v[72:73], v[42:43], v[42:43]
    v_pk_fma_f32 v[74:75], v[74:75], v[42:43], v[42:43]
    v_pk_fma_f32 v[76:77], v[76:77], v[42:43], v[42:43]
    v_pk_fma_f32 v[78:79], v[78:79], v[42:43], v[42:43]
    v_rcp_f32 v64, v64
    v_rcp_f32 v65, v65
    v_rcp_f32 v66, v66
    v_rcp_f32 v67, v67
    v_rcp_f32 v68, v68
    v_rcp_f32 v69, v69
    v_rcp_f32 v70, v70
    v_rcp_f32 v71, v71
    v_rcp_f32 v72, v72
    v_rcp_f32 v73, v73
    v_rcp_f32 v74, v74
    v_rcp_f32 v75, v75
    v_rcp_f32 v76, v76
    v_rcp_f32 v77, v77
    v_rcp_f32 v78, v78
    v_rcp_f32 v79, v79
    v_pk_mul_f32 v[64:65], v[64:65], v[88:89]
    v_pk_mul_f32 v[66:67], v[66:67], v[90:91]
    v_pk_mul_f32 v[68:69], v[68:69], v[92:93]
    v_pk_mul_f32 v[70:71], v[70:71], v[94:95]
    v_pk_mul_f32 v[72:73], v[72:73], v[96:97]
    v_pk_mul_f32 v[74:75], v[74:75], v[98:99]
    v_pk_mul_f32 v[76:77], v[76:77], v[100:101]
    v_pk_mul_f32 v[78:79], v[78:79], v[102:103]
    v_cvt_pk_bf16_f32 v128, v64, v65
    v_cvt_pk_bf16_f32 v129, v66, v67
    v_cvt_pk_bf16_f32 v130, v68, v69
    v_cvt_pk_bf16_f32 v131, v70, v71
    v_cvt_pk_bf16_f32 v132, v72, v73
    v_cvt_pk_bf16_f32 v133, v74, v75
    v_cvt_pk_bf16_f32 v134, v76, v77
    v_cvt_pk_bf16_f32 v135, v78, v79
    s_branch L_a_start
L_a_start:
    v_lshlrev_b32 v127, 4, v1
    s_cmp_eq_u32 s7, 2
    s_cbranch_scc1 L_a_helper
    s_setprio 3
    v_and_b32 v2, 31, v1
    v_lshrrev_b32 v3, 5, v1
    v_lshlrev_b32 v126, 4, v2
    v_mov_b32 v102, 163584
    v_mov_b32 v103, 1
    s_mul_i32 s30, s3, 10240
    s_add_u32 s30, s30, 0
    s_lshl_b32 s12, s66, 10
    s_add_u32 s12, s12, s30
    s_lshr_b32 s13, s66, 1
    s_and_b32 s13, s13, 1
    s_lshl_b32 s13, s13, 10
    s_lshl_b32 s14, s7, 9
    s_add_u32 s13, s13, s14
    s_and_b32 s14, s66, 1
    s_lshl_b32 s14, s14, 3
    s_add_u32 s13, s13, s14
    s_add_u32 s13, s13, s30
    s_add_u32 s13, s13, 8192
    v_add_u32 v14, 1344, v127
    v_lshlrev_b32 v15, 3, v2
    v_add_u32 v15, 2368, v15
    v_lshrrev_b32 v13, 2, v2
    v_or_b32 v13, 0x0c0c0c00, v13
    v_mov_b32 v16, 0x40d1100
    v_mov_b32 v17, 0xc0c080a
    v_perm_b32 v13, v17, v16, v13
    v_and_b32 v16, 3, v1
    v_mul_u32_u24 v17, 21, v3
    v_add3_u32 v13, v13, v16, v17
    v_lshlrev_b32 v13, 4, v13
    v_add_u32 v10, 1280, v13
    v_add_u32 v11, 1280, v14
    v_add_u32 v12, 1280, v15
    v_lshlrev_b32 v16, 3, v2
    s_mov_b32 exec_lo, 0xeecc0000
    s_mov_b32 exec_hi, 0xeecc0000
    v_mov_b32 v10, 0x40000
    s_mov_b32 exec_lo, 0
    s_mov_b32 exec_hi, -1
    v_mov_b32 v12, 0x40000
    s_mov_b64 exec, -1
    v_mov_b32 v64, 0
    v_mov_b32 v65, 0
    v_mov_b32 v66, 0
    v_mov_b32 v67, 0
    v_mov_b32 v68, 0
    v_mov_b32 v69, 0
    v_mov_b32 v70, 0
    v_mov_b32 v71, 0
    v_mov_b32 v72, 0
    v_mov_b32 v73, 0
    v_mov_b32 v74, 0
    v_mov_b32 v75, 0
    v_mov_b32 v76, 0
    v_mov_b32 v77, 0
    v_mov_b32 v78, 0
    v_mov_b32 v79, 0
    v_mov_b32 v84, 0
    v_mov_b32 v88, 0
    v_mov_b32 v85, 0
    v_mov_b32 v89, 0
    v_mov_b32 v86, 0
    v_mov_b32 v90, 0
    v_mov_b32 v87, 0
    v_mov_b32 v91, 0
    s_cmp_lg_u32 s66, 4
    s_cbranch_scc1 L_a_qw
    s_and_b32 s33, s3, 0xe0
    s_and_b32 s31, s3, 3
    s_lshl_b32 s31, s31, 1
    s_add_u32 s33, s33, s31
    s_bfe_u32 s31, s3, 0x10004
    s_add_u32 s33, s33, s31
    s_lshr_b32 s30, s33, 2
    s_mul_i32 s30, s30, 4224
    s_and_b32 s31, s33, 3
    s_lshl_b32 s31, s31, 3
    s_add_u32 s30, s30, s31
    s_add_u32 s30, s30, 14781440
    buffer_load_dwordx2 v[122:123], off, s[8:11], s30 offset:64 sc1
    s_waitcnt vmcnt(0)
    v_readfirstlane_b32 s30, v122
    v_readfirstlane_b32 s31, v123
    s_nop 1
    s_xor_b32 s30, s30, s64
    s_xor_b32 s31, s31, s54
    s_or_b32 s55, s30, s31
    s_lshr_b32 s30, s3, 2
    s_mul_i32 s30, s30, 4224
    s_add_u32 s30, s30, 14781440
    s_and_b32 s31, s3, 3
    s_lshl_b32 s31, s31, 7
    s_add_u32 s30, s30, s31
    s_add_u32 s30, s30, 128
    v_mov_b32 v123, s30
    s_cmp_eq_u32 s55, 0
    s_cselect_b32 s30, 2, 1
    v_mov_b32 v125, s30
    s_mov_b32 s68, 0
    s_mov_b32 s28, 0
L_a_qf:
    s_cmp_eq_u32 s55, 0
    s_cbranch_scc1 L_a_qf_t_l
    buffer_load_dword v122, v123, s[8:11], s68 offen sc1
    s_branch L_a_qf_t_e
L_a_qf_t_l:
    buffer_load_dword v122, v123, s[8:11], s68 offen nt
L_a_qf_t_e:
    s_add_u32 s28, s28, 1
    s_waitcnt vmcnt(0)
    v_cmp_ne_u32 vcc, s64, v122
    s_cbranch_vccz L_a_qf_ok
    s_sleep 1
    s_cmp_lt_u32 s28, 131072
    s_cbranch_scc1 L_a_qf
L_a_qf_ok:
    s_mov_b64 exec, 1
    ds_add_u32 v102, v125 offset:44
    s_mov_b64 exec, -1
L_a_qw:
    ds_read_b32 v124, v102 offset:44
    s_waitcnt lgkmcnt(0)
    v_readfirstlane_b32 s27, v124
    s_cmp_ge_u32 s27, 1
    s_cbranch_scc1 L_a_qw_ok
    s_sleep 1
    s_branch L_a_qw
L_a_qw_ok:
    s_sub_u32 s55, 2, s27
    s_cmp_eq_u32 s55, 0
    s_cbranch_scc1 L_a_ql_l
    buffer_load_dwordx4 v[4:7], v127, s[8:11], s12 offen sc1
    buffer_load_dwordx2 v[8:9], v126, s[8:11], s13 offen sc1
    s_branch L_a_ql_e
L_a_ql_l:
    buffer_load_dwordx4 v[4:7], v127, s[8:11], s12 offen nt
    buffer_load_dwordx2 v[8:9], v126, s[8:11], s13 offen nt
L_a_ql_e:
L_a_kva:
    ds_read_b32 v124, v102 offset:12
    s_waitcnt lgkmcnt(0)
    v_readfirstlane_b32 s27, v124
    s_cmp_ge_u32 s27, 5
    s_cbranch_scc1 L_a_kva_ok
    s_sleep 1
    s_branch L_a_kva
L_a_kva_ok:
    ds_read_b32 v18, v102 offset:24
    ds_read_b128 v[120:123], v127
    ds_read_b64 v[124:125], v16 offset:1024
    ds_read_b128 v[96:99], v11
    ds_read_b64 v[100:101], v12
    ds_read_b128 v[92:95], v10 offset:672
    s_waitcnt vmcnt(0)
    s_mov_b64 exec, 1
    ds_add_rtn_u32 v28, v102, v103 offset:64
    s_waitcnt lgkmcnt(0)
    v_readfirstlane_b32 s27, v28
    s_mov_b64 exec, -1
    s_cmp_lg_u32 s27, 7
    s_cbranch_scc1 L_a_now
    s_cmp_ge_u32 s2, 184
    s_cbranch_scc1 L_a_nw
    s_and_b32 s30, s2, 3
    s_mul_i32 s30, s30, 33792
    s_and_b32 s31, s2, 0xfc
    s_add_u32 s30, s30, s31
    s_add_u32 s30, s30, 15051776
    v_mul_u32_u24 v28, 4224, v1
    v_mov_b32 v29, s64
    s_mov_b32 exec_lo, 255
    s_mov_b32 exec_hi, 0
    buffer_store_dword v29, v28, s[8:11], s30 offen sc1
    s_mov_b64 exec, -1
L_a_nw:
L_a_now:
    s_mov_b32 exec_lo, 0
    v_mov_b32 v8, 0
    v_mov_b32 v9, 0
    s_mov_b64 exec, -1
    v_mov_b32 v2, 0
    v_dot2c_f32_bf16 v2, v4, v4
    v_dot2c_f32_bf16 v2, v5, v5
    v_dot2c_f32_bf16 v2, v6, v6
    v_dot2c_f32_bf16 v2, v7, v7
    v_dot2c_f32_bf16 v2, v8, v8
    v_dot2c_f32_bf16 v2, v9, v9
    s_nop 2
    v_mov_b32 v3, v2
    s_nop 1
    v_permlane32_swap_b32 v3, v2
    s_waitcnt lgkmcnt(0)
    s_nop 0
    v_add_f32 v2, v2, v3
    v_mul_f32 v2, v18, v2
    v_sqrt_f32 v2, v2
    s_nop 0
    v_sub_f32 v16, 0, v2
    v_mov_b32 v17, v16
    v_mov_b32 v18, v16
    v_mov_b32 v19, v16
    v_mov_b32 v20, v16
    v_mov_b32 v21, v16
    v_mov_b32 v22, v16
    v_mov_b32 v23, v16
    v_mov_b32 v24, v16
    v_mov_b32 v25, v16
    v_mov_b32 v26, v16
    v_mov_b32 v27, v16
    v_mov_b32 v28, v16
    v_mov_b32 v29, v16
    v_mov_b32 v30, v16
    v_mov_b32 v31, v16
    s_nop 1
    v_mfma_f32_32x32x16_bf16 v[32:47], v[120:123], v[4:7], v[16:31]
    v_mfma_f32_32x32x8_bf16 v[32:47], v[124:125], v[8:9], v[32:47]
    s_mov_b32 s24, 0
    s_setprio 2
    s_nop 9
.p2align 6
L_a_loop:
    s_waitcnt lgkmcnt(0)
    v_mfma_f32_32x32x16_bf16 v[48:63], v[96:99], v[4:7], v[16:31]
    ds_read_b128 v[112:115], v11 offset:2624
    v_exp_f32 v32, v32
    v_exp_f32 v33, v33
    v_exp_f32 v34, v34
    v_cvt_pk_bf16_f32 v80, v32, v33
    v_exp_f32 v35, v35
    v_mfma_f32_32x32x16_bf16 v[64:79], v[88:91], v[84:87], v[64:79]
    ds_read_b128 v[104:107], v10 offset:2624
    v_exp_f32 v36, v36
    v_cvt_pk_bf16_f32 v81, v34, v35
    v_exp_f32 v37, v37
    v_exp_f32 v38, v38
    v_cvt_pk_bf16_f32 v82, v36, v37
    v_exp_f32 v39, v39
    v_mfma_f32_32x32x8_bf16 v[48:63], v[100:101], v[8:9], v[48:63]
    ds_read_b64 v[116:117], v12 offset:2624
    v_exp_f32 v40, v40
    v_cvt_pk_bf16_f32 v83, v38, v39
    v_exp_f32 v41, v41
    v_exp_f32 v42, v42
    v_cvt_pk_bf16_f32 v84, v40, v41
    v_exp_f32 v43, v43
    v_mfma_f32_32x32x16_bf16 v[64:79], v[92:95], v[80:83], v[64:79]
    ds_read_b128 v[108:111], v10 offset:3296
    v_exp_f32 v44, v44
    v_cvt_pk_bf16_f32 v85, v42, v43
    v_exp_f32 v45, v45
    v_exp_f32 v46, v46
    v_exp_f32 v47, v47
    v_cvt_pk_bf16_f32 v86, v44, v45
    v_cvt_pk_bf16_f32 v87, v46, v47
    s_waitcnt lgkmcnt(0)
    v_mfma_f32_32x32x16_bf16 v[32:47], v[112:115], v[4:7], v[16:31]
    ds_read_b128 v[96:99], v11 offset:5248
    v_exp_f32 v48, v48
    v_exp_f32 v49, v49
    v_exp_f32 v50, v50
    v_cvt_pk_bf16_f32 v80, v48, v49
    v_exp_f32 v51, v51
    v_mfma_f32_32x32x16_bf16 v[64:79], v[104:107], v[84:87], v[64:79]
    ds_read_b128 v[88:91], v10 offset:5248
    v_exp_f32 v52, v52
    v_cvt_pk_bf16_f32 v81, v50, v51
    v_exp_f32 v53, v53
    v_exp_f32 v54, v54
    v_cvt_pk_bf16_f32 v82, v52, v53
    v_exp_f32 v55, v55
    v_mfma_f32_32x32x8_bf16 v[32:47], v[116:117], v[8:9], v[32:47]
    ds_read_b64 v[100:101], v12 offset:5248
    v_exp_f32 v56, v56
    v_cvt_pk_bf16_f32 v83, v54, v55
    v_exp_f32 v57, v57
    v_exp_f32 v58, v58
    v_cvt_pk_bf16_f32 v84, v56, v57
    v_exp_f32 v59, v59
    v_mfma_f32_32x32x16_bf16 v[64:79], v[108:111], v[80:83], v[64:79]
    ds_read_b128 v[92:95], v10 offset:5920
    v_exp_f32 v60, v60
    v_cvt_pk_bf16_f32 v85, v58, v59
    v_exp_f32 v61, v61
    v_exp_f32 v62, v62
    v_exp_f32 v63, v63
    v_cvt_pk_bf16_f32 v86, v60, v61
    v_cvt_pk_bf16_f32 v87, v62, v63
    s_waitcnt lgkmcnt(0)
    v_mfma_f32_32x32x16_bf16 v[48:63], v[96:99], v[4:7], v[16:31]
    ds_read_b128 v[112:115], v11 offset:7872
    v_exp_f32 v32, v32
    v_exp_f32 v33, v33
    v_exp_f32 v34, v34
    v_cvt_pk_bf16_f32 v80, v32, v33
    v_exp_f32 v35, v35
    v_mfma_f32_32x32x16_bf16 v[64:79], v[88:91], v[84:87], v[64:79]
    ds_read_b128 v[104:107], v10 offset:7872
    v_exp_f32 v36, v36
    v_cvt_pk_bf16_f32 v81, v34, v35
    v_exp_f32 v37, v37
    v_exp_f32 v38, v38
    v_cvt_pk_bf16_f32 v82, v36, v37
    v_exp_f32 v39, v39
    v_mfma_f32_32x32x8_bf16 v[48:63], v[100:101], v[8:9], v[48:63]
    ds_read_b64 v[116:117], v12 offset:7872
    v_exp_f32 v40, v40
    v_cvt_pk_bf16_f32 v83, v38, v39
    v_exp_f32 v41, v41
    v_exp_f32 v42, v42
    v_cvt_pk_bf16_f32 v84, v40, v41
    v_exp_f32 v43, v43
    v_mfma_f32_32x32x16_bf16 v[64:79], v[92:95], v[80:83], v[64:79]
    ds_read_b128 v[108:111], v10 offset:8544
    v_exp_f32 v44, v44
    v_cvt_pk_bf16_f32 v85, v42, v43
    v_exp_f32 v45, v45
    v_exp_f32 v46, v46
    v_exp_f32 v47, v47
    v_cvt_pk_bf16_f32 v86, v44, v45
    v_cvt_pk_bf16_f32 v87, v46, v47
    s_waitcnt lgkmcnt(0)
    v_mfma_f32_32x32x16_bf16 v[32:47], v[112:115], v[4:7], v[16:31]
    ds_read_b128 v[96:99], v11 offset:10496
    v_exp_f32 v48, v48
    v_exp_f32 v49, v49
    v_exp_f32 v50, v50
    v_cvt_pk_bf16_f32 v80, v48, v49
    v_exp_f32 v51, v51
    v_mfma_f32_32x32x16_bf16 v[64:79], v[104:107], v[84:87], v[64:79]
    ds_read_b128 v[88:91], v10 offset:10496
    v_exp_f32 v52, v52
    v_cvt_pk_bf16_f32 v81, v50, v51
    v_exp_f32 v53, v53
    v_exp_f32 v54, v54
    v_cvt_pk_bf16_f32 v82, v52, v53
    v_exp_f32 v55, v55
    v_mfma_f32_32x32x8_bf16 v[32:47], v[116:117], v[8:9], v[32:47]
    ds_read_b64 v[100:101], v12 offset:10496
    v_exp_f32 v56, v56
    v_cvt_pk_bf16_f32 v83, v54, v55
    v_exp_f32 v57, v57
    v_exp_f32 v58, v58
    v_cvt_pk_bf16_f32 v84, v56, v57
    v_exp_f32 v59, v59
    v_mfma_f32_32x32x16_bf16 v[64:79], v[108:111], v[80:83], v[64:79]
    ds_read_b128 v[92:95], v10 offset:11168
    v_exp_f32 v60, v60
    v_cvt_pk_bf16_f32 v85, v58, v59
    v_exp_f32 v61, v61
    v_exp_f32 v62, v62
    v_exp_f32 v63, v63
    v_cvt_pk_bf16_f32 v86, v60, v61
    v_cvt_pk_bf16_f32 v87, v62, v63
    s_cmp_eq_u32 s24, s67
    s_cbranch_scc1 L_a_mid
L_a_mret:
    s_waitcnt lgkmcnt(0)
    v_mfma_f32_32x32x16_bf16 v[48:63], v[96:99], v[4:7], v[16:31]
    ds_read_b128 v[112:115], v11 offset:13120
    v_exp_f32 v32, v32
    v_exp_f32 v33, v33
    v_exp_f32 v34, v34
    v_cvt_pk_bf16_f32 v80, v32, v33
    v_exp_f32 v35, v35
    v_mfma_f32_32x32x16_bf16 v[64:79], v[88:91], v[84:87], v[64:79]
    ds_read_b128 v[104:107], v10 offset:13120
    v_exp_f32 v36, v36
    v_cvt_pk_bf16_f32 v81, v34, v35
    v_exp_f32 v37, v37
    v_exp_f32 v38, v38
    v_cvt_pk_bf16_f32 v82, v36, v37
    v_exp_f32 v39, v39
    v_mfma_f32_32x32x8_bf16 v[48:63], v[100:101], v[8:9], v[48:63]
    ds_read_b64 v[116:117], v12 offset:13120
    v_exp_f32 v40, v40
    v_cvt_pk_bf16_f32 v83, v38, v39
    v_exp_f32 v41, v41
    v_exp_f32 v42, v42
    v_cvt_pk_bf16_f32 v84, v40, v41
    v_exp_f32 v43, v43
    v_mfma_f32_32x32x16_bf16 v[64:79], v[92:95], v[80:83], v[64:79]
    ds_read_b128 v[108:111], v10 offset:13792
    v_exp_f32 v44, v44
    v_cvt_pk_bf16_f32 v85, v42, v43
    v_exp_f32 v45, v45
    v_exp_f32 v46, v46
    v_exp_f32 v47, v47
    v_cvt_pk_bf16_f32 v86, v44, v45
    v_cvt_pk_bf16_f32 v87, v46, v47
    s_waitcnt lgkmcnt(0)
    v_mfma_f32_32x32x16_bf16 v[32:47], v[112:115], v[4:7], v[16:31]
    ds_read_b128 v[96:99], v11 offset:15744
    v_exp_f32 v48, v48
    v_exp_f32 v49, v49
    v_exp_f32 v50, v50
    v_cvt_pk_bf16_f32 v80, v48, v49
    v_exp_f32 v51, v51
    v_mfma_f32_32x32x16_bf16 v[64:79], v[104:107], v[84:87], v[64:79]
    ds_read_b128 v[88:91], v10 offset:15744
    v_exp_f32 v52, v52
    v_cvt_pk_bf16_f32 v81, v50, v51
    v_exp_f32 v53, v53
    v_exp_f32 v54, v54
    v_cvt_pk_bf16_f32 v82, v52, v53
    v_exp_f32 v55, v55
    v_mfma_f32_32x32x8_bf16 v[32:47], v[116:117], v[8:9], v[32:47]
    ds_read_b64 v[100:101], v12 offset:15744
    v_exp_f32 v56, v56
    v_cvt_pk_bf16_f32 v83, v54, v55
    v_exp_f32 v57, v57
    v_exp_f32 v58, v58
    v_cvt_pk_bf16_f32 v84, v56, v57
    v_exp_f32 v59, v59
    v_mfma_f32_32x32x16_bf16 v[64:79], v[108:111], v[80:83], v[64:79]
    ds_read_b128 v[92:95], v10 offset:16416
    v_exp_f32 v60, v60
    v_cvt_pk_bf16_f32 v85, v58, v59
    v_exp_f32 v61, v61
    v_exp_f32 v62, v62
    v_exp_f32 v63, v63
    v_cvt_pk_bf16_f32 v86, v60, v61
    v_cvt_pk_bf16_f32 v87, v62, v63
    s_waitcnt lgkmcnt(0)
    v_mfma_f32_32x32x16_bf16 v[48:63], v[96:99], v[4:7], v[16:31]
    ds_read_b128 v[112:115], v11 offset:18368
    v_exp_f32 v32, v32
    v_exp_f32 v33, v33
    v_exp_f32 v34, v34
    v_cvt_pk_bf16_f32 v80, v32, v33
    v_exp_f32 v35, v35
    v_mfma_f32_32x32x16_bf16 v[64:79], v[88:91], v[84:87], v[64:79]
    ds_read_b128 v[104:107], v10 offset:18368
    v_exp_f32 v36, v36
    v_cvt_pk_bf16_f32 v81, v34, v35
    v_exp_f32 v37, v37
    v_exp_f32 v38, v38
    v_cvt_pk_bf16_f32 v82, v36, v37
    v_exp_f32 v39, v39
    v_mfma_f32_32x32x8_bf16 v[48:63], v[100:101], v[8:9], v[48:63]
    ds_read_b64 v[116:117], v12 offset:18368
    v_exp_f32 v40, v40
    v_cvt_pk_bf16_f32 v83, v38, v39
    v_exp_f32 v41, v41
    v_exp_f32 v42, v42
    v_cvt_pk_bf16_f32 v84, v40, v41
    v_exp_f32 v43, v43
    v_mfma_f32_32x32x16_bf16 v[64:79], v[92:95], v[80:83], v[64:79]
    ds_read_b128 v[108:111], v10 offset:19040
    v_exp_f32 v44, v44
    v_cvt_pk_bf16_f32 v85, v42, v43
    v_exp_f32 v45, v45
    v_exp_f32 v46, v46
    v_exp_f32 v47, v47
    v_cvt_pk_bf16_f32 v86, v44, v45
    v_cvt_pk_bf16_f32 v87, v46, v47
    s_waitcnt lgkmcnt(0)
    v_mfma_f32_32x32x16_bf16 v[32:47], v[112:115], v[4:7], v[16:31]
    ds_read_b128 v[96:99], v11 offset:20992
    v_exp_f32 v48, v48
    v_exp_f32 v49, v49
    v_exp_f32 v50, v50
    v_cvt_pk_bf16_f32 v80, v48, v49
    v_exp_f32 v51, v51
    v_mfma_f32_32x32x16_bf16 v[64:79], v[104:107], v[84:87], v[64:79]
    ds_read_b128 v[88:91], v10 offset:20992
    v_exp_f32 v52, v52
    v_cvt_pk_bf16_f32 v81, v50, v51
    v_exp_f32 v53, v53
    v_exp_f32 v54, v54
    v_cvt_pk_bf16_f32 v82, v52, v53
    v_exp_f32 v55, v55
    v_mfma_f32_32x32x8_bf16 v[32:47], v[116:117], v[8:9], v[32:47]
    ds_read_b64 v[100:101], v12 offset:20992
    v_exp_f32 v56, v56
    v_cvt_pk_bf16_f32 v83, v54, v55
    v_exp_f32 v57, v57
    v_exp_f32 v58, v58
    v_cvt_pk_bf16_f32 v84, v56, v57
    v_exp_f32 v59, v59
    v_mfma_f32_32x32x16_bf16 v[64:79], v[108:111], v[80:83], v[64:79]
    ds_read_b128 v[92:95], v10 offset:21664
    v_exp_f32 v60, v60
    v_cvt_pk_bf16_f32 v85, v58, v59
    v_exp_f32 v61, v61
    v_exp_f32 v62, v62
    v_exp_f32 v63, v63
    v_cvt_pk_bf16_f32 v86, v60, v61
    v_cvt_pk_bf16_f32 v87, v62, v63
    v_add_u32 v10, 20992, v10
    v_add_u32 v11, 20992, v11
    v_add_u32 v12, 20992, v12
    s_add_u32 s24, s24, 1
    s_cmp_eq_u32 s24, 1
    s_cbranch_scc1 L_a_e1
    s_cmp_eq_u32 s24, 2
    s_cbranch_scc1 L_a_e2
    s_cmp_eq_u32 s24, 3
    s_cbranch_scc1 L_a_loop
    s_cmp_eq_u32 s24, 4
    s_cbranch_scc1 L_a_e4
    s_cmp_eq_u32 s24, 5
    s_cbranch_scc1 L_a_e5
    s_cmp_eq_u32 s24, 6
    s_cbranch_scc1 L_a_e6
    s_cmp_ge_u32 s66, 4
    s_cbranch_scc1 L_a_lp
    s_setprio 0
L_a_lp:
    s_waitcnt lgkmcnt(0)
    v_mfma_f32_32x32x16_bf16 v[48:63], v[96:99], v[4:7], v[16:31]
    ds_read_b128 v[112:115], v11 offset:2624
    v_exp_f32 v32, v32
    v_exp_f32 v33, v33
    v_exp_f32 v34, v34
    v_cvt_pk_bf16_f32 v80, v32, v33
    v_exp_f32 v35, v35
    v_mfma_f32_32x32x16_bf16 v[64:79], v[88:91], v[84:87], v[64:79]
    ds_read_b128 v[104:107], v10 offset:2624
    v_exp_f32 v36, v36
    v_cvt_pk_bf16_f32 v81, v34, v35
    v_exp_f32 v37, v37
    v_exp_f32 v38, v38
    v_cvt_pk_bf16_f32 v82, v36, v37
    v_exp_f32 v39, v39
    v_mfma_f32_32x32x8_bf16 v[48:63], v[100:101], v[8:9], v[48:63]
    ds_read_b64 v[116:117], v12 offset:2624
    v_exp_f32 v40, v40
    v_cvt_pk_bf16_f32 v83, v38, v39
    v_exp_f32 v41, v41
    v_exp_f32 v42, v42
    v_cvt_pk_bf16_f32 v84, v40, v41
    v_exp_f32 v43, v43
    v_mfma_f32_32x32x16_bf16 v[64:79], v[92:95], v[80:83], v[64:79]
    ds_read_b128 v[108:111], v10 offset:3296
    v_exp_f32 v44, v44
    v_cvt_pk_bf16_f32 v85, v42, v43
    v_exp_f32 v45, v45
    v_exp_f32 v46, v46
    v_exp_f32 v47, v47
    v_cvt_pk_bf16_f32 v86, v44, v45
    v_cvt_pk_bf16_f32 v87, v46, v47
    s_waitcnt lgkmcnt(0)
    v_mfma_f32_32x32x16_bf16 v[32:47], v[112:115], v[4:7], v[16:31]
    ds_read_b128 v[96:99], v11 offset:5248
    v_exp_f32 v48, v48
    v_exp_f32 v49, v49
    v_exp_f32 v50, v50
    v_cvt_pk_bf16_f32 v80, v48, v49
    v_exp_f32 v51, v51
    v_mfma_f32_32x32x16_bf16 v[64:79], v[104:107], v[84:87], v[64:79]
    ds_read_b128 v[88:91], v10 offset:5248
    v_exp_f32 v52, v52
    v_cvt_pk_bf16_f32 v81, v50, v51
    v_exp_f32 v53, v53
    v_exp_f32 v54, v54
    v_cvt_pk_bf16_f32 v82, v52, v53
    v_exp_f32 v55, v55
    v_mfma_f32_32x32x8_bf16 v[32:47], v[116:117], v[8:9], v[32:47]
    ds_read_b64 v[100:101], v12 offset:5248
    v_exp_f32 v56, v56
    v_cvt_pk_bf16_f32 v83, v54, v55
    v_exp_f32 v57, v57
    v_exp_f32 v58, v58
    v_cvt_pk_bf16_f32 v84, v56, v57
    v_exp_f32 v59, v59
    v_mfma_f32_32x32x16_bf16 v[64:79], v[108:111], v[80:83], v[64:79]
    ds_read_b128 v[92:95], v10 offset:5920
    v_exp_f32 v60, v60
    v_cvt_pk_bf16_f32 v85, v58, v59
    v_exp_f32 v61, v61
    v_exp_f32 v62, v62
    v_exp_f32 v63, v63
    v_cvt_pk_bf16_f32 v86, v60, v61
    v_cvt_pk_bf16_f32 v87, v62, v63
    s_waitcnt lgkmcnt(0)
    v_mfma_f32_32x32x16_bf16 v[48:63], v[96:99], v[4:7], v[16:31]
    ds_read_b128 v[112:115], v11 offset:7872
    v_exp_f32 v32, v32
    v_exp_f32 v33, v33
    v_exp_f32 v34, v34
    v_cvt_pk_bf16_f32 v80, v32, v33
    v_exp_f32 v35, v35
    v_mfma_f32_32x32x16_bf16 v[64:79], v[88:91], v[84:87], v[64:79]
    ds_read_b128 v[104:107], v10 offset:7872
    v_exp_f32 v36, v36
    v_cvt_pk_bf16_f32 v81, v34, v35
    v_exp_f32 v37, v37
    v_exp_f32 v38, v38
    v_cvt_pk_bf16_f32 v82, v36, v37
    v_exp_f32 v39, v39
    v_mfma_f32_32x32x8_bf16 v[48:63], v[100:101], v[8:9], v[48:63]
    ds_read_b64 v[116:117], v12 offset:7872
    v_exp_f32 v40, v40
    v_cvt_pk_bf16_f32 v83, v38, v39
    v_exp_f32 v41, v41
    v_exp_f32 v42, v42
    v_cvt_pk_bf16_f32 v84, v40, v41
    v_exp_f32 v43, v43
    v_mfma_f32_32x32x16_bf16 v[64:79], v[92:95], v[80:83], v[64:79]
    ds_read_b128 v[108:111], v10 offset:8544
    v_exp_f32 v44, v44
    v_cvt_pk_bf16_f32 v85, v42, v43
    v_exp_f32 v45, v45
    v_exp_f32 v46, v46
    v_exp_f32 v47, v47
    v_cvt_pk_bf16_f32 v86, v44, v45
    v_cvt_pk_bf16_f32 v87, v46, v47
    s_waitcnt lgkmcnt(0)
    v_mfma_f32_32x32x16_bf16 v[32:47], v[112:115], v[4:7], v[16:31]
    ds_read_b128 v[96:99], v11 offset:10496
    v_exp_f32 v48, v48
    v_exp_f32 v49, v49
    v_exp_f32 v50, v50
    v_cvt_pk_bf16_f32 v80, v48, v49
    v_exp_f32 v51, v51
    v_mfma_f32_32x32x16_bf16 v[64:79], v[104:107], v[84:87], v[64:79]
    ds_read_b128 v[88:91], v10 offset:10496
    v_exp_f32 v52, v52
    v_cvt_pk_bf16_f32 v81, v50, v51
    v_exp_f32 v53, v53
    v_exp_f32 v54, v54
    v_cvt_pk_bf16_f32 v82, v52, v53
    v_exp_f32 v55, v55
    v_mfma_f32_32x32x8_bf16 v[32:47], v[116:117], v[8:9], v[32:47]
    ds_read_b64 v[100:101], v12 offset:10496
    v_exp_f32 v56, v56
    v_cvt_pk_bf16_f32 v83, v54, v55
    v_exp_f32 v57, v57
    v_exp_f32 v58, v58
    v_cvt_pk_bf16_f32 v84, v56, v57
    v_exp_f32 v59, v59
    v_mfma_f32_32x32x16_bf16 v[64:79], v[108:111], v[80:83], v[64:79]
    ds_read_b128 v[92:95], v10 offset:11168
    v_exp_f32 v60, v60
    v_cvt_pk_bf16_f32 v85, v58, v59
    v_exp_f32 v61, v61
    v_exp_f32 v62, v62
    v_exp_f32 v63, v63
    v_cvt_pk_bf16_f32 v86, v60, v61
    v_cvt_pk_bf16_f32 v87, v62, v63
    s_waitcnt lgkmcnt(0)
    v_mfma_f32_32x32x16_bf16 v[48:63], v[96:99], v[4:7], v[16:31]
    v_exp_f32 v32, v32
    v_exp_f32 v33, v33
    v_exp_f32 v34, v34
    v_cvt_pk_bf16_f32 v80, v32, v33
    v_exp_f32 v35, v35
    v_mfma_f32_32x32x16_bf16 v[64:79], v[88:91], v[84:87], v[64:79]
    ds_read_b128 v[104:107], v10 offset:13120
    v_exp_f32 v36, v36
    v_cvt_pk_bf16_f32 v81, v34, v35
    v_exp_f32 v37, v37
    v_exp_f32 v38, v38
    v_cvt_pk_bf16_f32 v82, v36, v37
    v_exp_f32 v39, v39
    v_mfma_f32_32x32x8_bf16 v[48:63], v[100:101], v[8:9], v[48:63]
    v_exp_f32 v40, v40
    v_cvt_pk_bf16_f32 v83, v38, v39
    v_exp_f32 v41, v41
    v_exp_f32 v42, v42
    v_cvt_pk_bf16_f32 v84, v40, v41
    v_exp_f32 v43, v43
    v_mfma_f32_32x32x16_bf16 v[64:79], v[92:95], v[80:83], v[64:79]
    ds_read_b128 v[108:111], v10 offset:13792
    v_exp_f32 v44, v44
    v_cvt_pk_bf16_f32 v85, v42, v43
    v_exp_f32 v45, v45
    v_exp_f32 v46, v46
    v_exp_f32 v47, v47
    v_cvt_pk_bf16_f32 v86, v44, v45
    v_cvt_pk_bf16_f32 v87, v46, v47
    s_waitcnt lgkmcnt(0)
    s_mov_b64 exec, 1
    ds_add_u32 v102, v103 offset:8
    s_mov_b64 exec, -1
L_a_clro:
    ds_read_b32 v124, v102 offset:40
    s_waitcnt lgkmcnt(0)
    v_readfirstlane_b32 s27, v124
    s_cmp_ge_u32 s27, 4
    s_cbranch_scc1 L_a_clro_ok
    s_sleep 1
    s_branch L_a_clro
L_a_clro_ok:
    s_waitcnt vmcnt(0)
    v_mfma_f32_32x32x16_bf16 v[32:47], v[130:133], v[4:7], v[16:31]
    v_exp_f32 v48, v48
    v_exp_f32 v49, v49
    v_exp_f32 v50, v50
    v_cvt_pk_bf16_f32 v80, v48, v49
    v_exp_f32 v51, v51
    v_mfma_f32_32x32x16_bf16 v[64:79], v[104:107], v[84:87], v[64:79]
    v_exp_f32 v52, v52
    v_cvt_pk_bf16_f32 v81, v50, v51
    v_exp_f32 v53, v53
    v_exp_f32 v54, v54
    v_cvt_pk_bf16_f32 v82, v52, v53
    v_exp_f32 v55, v55
    v_mfma_f32_32x32x8_bf16 v[32:47], v[134:135], v[8:9], v[32:47]
    v_exp_f32 v56, v56
    v_cvt_pk_bf16_f32 v83, v54, v55
    v_exp_f32 v57, v57
    v_exp_f32 v58, v58
    v_cvt_pk_bf16_f32 v84, v56, v57
    v_exp_f32 v59, v59
    v_mfma_f32_32x32x16_bf16 v[64:79], v[108:111], v[80:83], v[64:79]
    v_exp_f32 v60, v60
    v_cvt_pk_bf16_f32 v85, v58, v59
    v_exp_f32 v61, v61
    v_exp_f32 v62, v62
    v_exp_f32 v63, v63
    v_cvt_pk_bf16_f32 v86, v60, v61
    v_cvt_pk_bf16_f32 v87, v62, v63
    s_waitcnt lgkmcnt(0)
    v_mfma_f32_32x32x16_bf16 v[48:63], v[144:147], v[4:7], v[16:31]
    v_exp_f32 v32, v32
    v_exp_f32 v33, v33
    v_exp_f32 v34, v34
    v_cvt_pk_bf16_f32 v80, v32, v33
    v_exp_f32 v35, v35
    v_mfma_f32_32x32x16_bf16 v[64:79], v[136:139], v[84:87], v[64:79]
    v_exp_f32 v36, v36
    v_cvt_pk_bf16_f32 v81, v34, v35
    v_exp_f32 v37, v37
    v_exp_f32 v38, v38
    v_cvt_pk_bf16_f32 v82, v36, v37
    v_exp_f32 v39, v39
    v_mfma_f32_32x32x8_bf16 v[48:63], v[148:149], v[8:9], v[48:63]
    v_exp_f32 v40, v40
    v_cvt_pk_bf16_f32 v83, v38, v39
    v_exp_f32 v41, v41
    v_exp_f32 v42, v42
    v_cvt_pk_bf16_f32 v84, v40, v41
    v_exp_f32 v43, v43
    v_mfma_f32_32x32x16_bf16 v[64:79], v[140:143], v[80:83], v[64:79]
    v_exp_f32 v44, v44
    v_cvt_pk_bf16_f32 v85, v42, v43
    v_exp_f32 v45, v45
    v_exp_f32 v46, v46
    v_exp_f32 v47, v47
    v_cvt_pk_bf16_f32 v86, v44, v45
    v_cvt_pk_bf16_f32 v87, v46, v47
    s_waitcnt lgkmcnt(0)
    v_exp_f32 v48, v48
    v_exp_f32 v49, v49
    v_exp_f32 v50, v50
    v_cvt_pk_bf16_f32 v80, v48, v49
    v_exp_f32 v51, v51
    v_mfma_f32_32x32x16_bf16 v[64:79], v[150:153], v[84:87], v[64:79]
    v_exp_f32 v52, v52
    v_cvt_pk_bf16_f32 v81, v50, v51
    v_exp_f32 v53, v53
    v_exp_f32 v54, v54
    v_cvt_pk_bf16_f32 v82, v52, v53
    v_exp_f32 v55, v55
    v_exp_f32 v56, v56
    v_cvt_pk_bf16_f32 v83, v54, v55
    v_exp_f32 v57, v57
    v_exp_f32 v58, v58
    v_cvt_pk_bf16_f32 v84, v56, v57
    v_exp_f32 v59, v59
    v_mfma_f32_32x32x16_bf16 v[64:79], v[154:157], v[80:83], v[64:79]
    v_exp_f32 v60, v60
    v_cvt_pk_bf16_f32 v85, v58, v59
    v_exp_f32 v61, v61
    v_exp_f32 v62, v62
    v_exp_f32 v63, v63
    v_cvt_pk_bf16_f32 v86, v60, v61
    v_cvt_pk_bf16_f32 v87, v62, v63
    s_nop 1
    v_mfma_f32_32x32x16_bf16 v[64:79], v[158:161], v[84:87], v[64:79]
    s_mov_b32 s26, 0x12800000
    s_lshr_b32 s12, s3, 2
    s_mul_i32 s12, s12, 136
    s_and_b32 s13, s3, 3
    s_lshl_b32 s13, s13, 3
    s_add_u32 s13, s13, s66
    s_add_u32 s14, s12, s13
    s_lshl_b32 s14, s14, 10
    s_add_u32 s14, s14, 2621440
    s_lshr_b32 s15, s13, 2
    s_add_u32 s15, s15, s12
    s_lshl_b32 s15, s15, 10
    s_and_b32 s13, s13, 3
    s_lshl_b32 s13, s13, 2
    s_add_u32 s15, s15, s13
    s_add_u32 s15, s15, 2654208
    v_cmp_ne_u32 s[32:33], s64, v162
    v_cmp_ne_u32 s[34:35], s54, v163
    v_mov_b32 v164, s64
    s_lshr_b32 s29, s3, 2
    s_mul_i32 s29, s29, 4224
    s_and_b32 s31, s3, 3
    s_lshl_b32 s31, s31, 7
    s_add_u32 s29, s29, s31
    s_lshl_b32 s31, s66, 2
    s_add_u32 s29, s29, s31
    s_add_u32 s29, s29, 14782080
    s_or_b32 s55, s32, s34
    v_cmp_nle_f32 vcc, s26, v76
    s_cbranch_vccnz L_a_fallback
L_a_fin:
    v_rcp_f32 v2, v76
    s_nop 0
    v_mul_f32 v64, v64, v2
    v_mul_f32 v65, v65, v2
    v_mul_f32 v66, v66, v2
    v_mul_f32 v67, v67, v2
    v_mul_f32 v68, v68, v2
    v_mul_f32 v69, v69, v2
    v_mul_f32 v70, v70, v2
    v_mul_f32 v71, v71, v2
    v_mul_f32 v72, v72, v2
    v_mul_f32 v73, v73, v2
    v_cvt_pk_bf16_f32 v80, v64, v65
    v_cvt_pk_bf16_f32 v81, v66, v67
    v_cvt_pk_bf16_f32 v82, v68, v69
    v_cvt_pk_bf16_f32 v83, v70, v71
    v_cvt_pk_bf16_f32 v84, v72, v73
    s_cmp_eq_u32 s55, 0
    s_cbranch_scc1 L_a_os_l
    buffer_store_dwordx4 v[80:83], v127, s[8:11], s14 offen sc1
    buffer_store_dword v84, v127, s[8:11], s15 offen sc1
    s_branch L_a_os_e
L_a_os_l:
    buffer_store_dwordx4 v[80:83], v127, s[8:11], s14 offen
    buffer_store_dword v84, v127, s[8:11], s15 offen
L_a_os_e:
    s_mov_b64 exec, 1
    ds_add_u32 v102, v103 offset:80
    s_cmp_eq_u32 s55, 0
    s_cbranch_scc1 L_a_oh2_l
    buffer_store_dword v164, off, s[8:11], s29 sc1
    s_branch L_a_oh2_e
L_a_oh2_l:
    buffer_store_dword v164, off, s[8:11], s29
L_a_oh2_e:
    s_mov_b64 exec, -1
L_end:
    s_endpgm
L_a_e1:
L_a_kva2:
    ds_read_b32 v124, v102 offset:92
    s_waitcnt lgkmcnt(0)
    v_readfirstlane_b32 s27, v124
    s_cmp_ge_u32 s27, 4
    s_cbranch_scc1 L_a_kva2_ok
    s_sleep 1
    s_branch L_a_kva2
L_a_kva2_ok:
    s_cmp_eq_u32 s67, 0
    s_cbranch_scc1 L_a_loop
    buffer_store_dwordx4 v[128:131], v127, s[8:11], s65 offen sc1
    buffer_store_dwordx4 v[132:135], v127, s[8:11], s65 offen offset:1024 sc1
    s_add_u32 s65, s65, 2048
    buffer_store_dwordx4 v[136:139], v127, s[8:11], s65 offen sc1
    buffer_store_dwordx4 v[140:143], v127, s[8:11], s65 offen offset:1024 sc1
    s_add_u32 s65, s65, 2048
    buffer_store_dwordx4 v[144:147], v127, s[8:11], s65 offen sc1
    buffer_store_dwordx4 v[148:151], v127, s[8:11], s65 offen offset:1024 sc1
    s_add_u32 s65, s65, 2048
    s_cmp_eq_u32 s69, 13
    s_cbranch_scc1 L_a_loop
    buffer_store_dwordx4 v[152:155], v127, s[8:11], s65 offen sc1
    buffer_store_dwordx4 v[156:159], v127, s[8:11], s65 offen offset:1024 sc1
    s_add_u32 s65, s65, 2048
    buffer_store_dwordx4 v[160:163], v127, s[8:11], s65 offen sc1
    buffer_store_dwordx4 v[164:167], v127, s[8:11], s65 offen offset:1024 sc1
    s_add_u32 s65, s65, 2048
    s_branch L_a_loop
L_a_e2:
L_a_kvb:
    ds_read_b32 v124, v102 offset:32
    s_waitcnt lgkmcnt(0)
    v_readfirstlane_b32 s27, v124
    s_cmp_ge_u32 s27, 4
    s_cbranch_scc1 L_a_kvb_ok
    s_sleep 1
    s_branch L_a_kvb
L_a_kvb_ok:
    s_branch L_a_loop
L_a_mid:
    s_cmp_eq_u32 s67, 0
    s_cbranch_scc1 L_a_mret
    s_waitcnt vmcnt(0)
    s_mov_b64 exec, 1
    ds_add_rtn_u32 v124, v102, v103 offset:20
    s_waitcnt lgkmcnt(0)
    v_readfirstlane_b32 s27, v124
    s_mov_b64 exec, -1
    s_cmp_lg_u32 s27, 3
    s_cbranch_scc1 L_a_mret
    s_sub_u32 s30, s2, 64
    s_cmp_ge_u32 s30, 160
    s_cbranch_scc1 L_a_mret
    s_lshr_b32 s31, s30, 5
    s_and_b32 s30, s2, 1
    s_mul_i32 s30, s30, 5
    s_add_u32 s31, s31, s30
    s_and_b32 s30, s2, 6
    s_lshl_b32 s30, s30, 1
    s_bfe_u32 s32, s2, 0x20003
    s_add_u32 s30, s30, s32
    s_mul_i32 s30, s30, 4224
    s_lshl_b32 s31, s31, 2
    s_add_u32 s30, s30, s31
    s_add_u32 s30, s30, 14713856
    v_mul_u32_u24 v122, 4224, v1
    v_mov_b32 v123, s64
    s_mov_b32 exec_lo, 1
    s_mov_b32 exec_hi, 0
    buffer_store_dword v123, v122, s[8:11], s30 offen sc1
    s_mov_b64 exec, -1
    s_branch L_a_mret
L_a_e4:
    s_mov_b64 exec, 1
    ds_add_u32 v102, v103 offset:0
    s_mov_b64 exec, -1
L_a_kvc:
    ds_read_b32 v124, v102 offset:16
    s_waitcnt lgkmcnt(0)
    v_readfirstlane_b32 s27, v124
    s_cmp_ge_u32 s27, 4
    s_cbranch_scc1 L_a_kvc_ok
    s_sleep 1
    s_branch L_a_kvc
L_a_kvc_ok:
    s_branch L_a_loop
L_a_e5:
    s_setprio 1
    s_mov_b32 s20, 14580608
    s_mov_b32 s21, 14583232
    s_mov_b32 s22, 14585856
    s_mov_b32 s23, 14588480
    buffer_load_dwordx4 v[130:133], v14, s[8:11], s20 offen sc1
    buffer_load_dwordx2 v[134:135], v15, s[8:11], s20 offen sc1
    buffer_load_dwordx4 v[136:139], v13, s[8:11], s21 offen sc1
    buffer_load_dwordx4 v[140:143], v13, s[8:11], s21 offen offset:672 sc1
    buffer_load_dwordx4 v[144:147], v14, s[8:11], s21 offen sc1
    buffer_load_dwordx2 v[148:149], v15, s[8:11], s21 offen sc1
    buffer_load_dwordx4 v[150:153], v13, s[8:11], s22 offen sc1
    buffer_load_dwordx4 v[154:157], v13, s[8:11], s22 offen offset:672 sc1
    buffer_load_dwordx4 v[158:161], v13, s[8:11], s23 offen sc1
    v_and_b32 v164, 3, v1
    v_lshlrev_b32 v164, 3, v164
    s_lshr_b32 s30, s3, 2
    s_mul_i32 s30, s30, 4224
    s_add_u32 s30, s30, 14781440
    buffer_load_dwordx2 v[162:163], v164, s[8:11], s30 offen offset:64 sc1
    s_branch L_a_loop
L_a_e6:
    s_mov_b64 exec, 1
    ds_add_u32 v102, v103 offset:4
    s_mov_b64 exec, -1
    s_branch L_a_loop
L_a_helper:
    v_mov_b32 v2, v127
    v_mov_b32 v4, 0
    v_mov_b32 v10, v1
    s_setprio 2
    s_mov_b32 s28, 0
L_a_tag:
    buffer_load_dword v8, v4, s[16:19], 0 offen sc1
    s_add_u32 s28, s28, 1
    s_waitcnt vmcnt(0)
    v_readfirstlane_b32 s64, v8
    s_cmp_lg_u32 s64, 0
    s_cbranch_scc1 L_a_tag_ok
    s_sleep 2
    s_cmp_lt_u32 s28, 131072
    s_cbranch_scc1 L_a_tag
L_a_tag_ok:
    v_mov_b32 v0, 163584
    v_mov_b32 v5, 1
    s_lshl_b32 s22, s6, 10
    s_add_u32 s23, s22, 14419264
    v_and_b32 v9, 31, v1
    v_lshlrev_b32 v9, 3, v9
    s_cmp_lg_u32 s6, 0
    s_cbranch_scc1 L_a_kvf
    s_lshr_b32 s68, s3, 5
    s_mul_i32 s68, s68, 4224
    s_add_u32 s68, s68, 14680064
    s_mov_b32 s28, 0
L_a_kvp:
    buffer_load_dwordx2 v[6:7], v9, s[8:11], s68 offen sc1
    s_add_u32 s28, s28, 1
    s_waitcnt vmcnt(0)
    v_cmp_ne_u32 vcc, s64, v6
    s_and_b32 s27, vcc_lo, 0x3ff
    s_cbranch_scc0 L_a_kvp_ok
    s_sleep 3
    s_cmp_lt_u32 s28, 131072
    s_cbranch_scc1 L_a_kvp
L_a_kvp_ok:
    s_mov_b64 exec, 1
    ds_add_u32 v0, v5 offset:60
    s_mov_b64 exec, -1
L_a_kvf:
    ds_read_b32 v3, v0 offset:60
    s_waitcnt lgkmcnt(0)
    v_readfirstlane_b32 s27, v3
    s_cmp_ge_u32 s27, 1
    s_cbranch_scc1 L_a_kvf_ok
    s_sleep 1
    s_branch L_a_kvf
L_a_kvf_ok:
    s_cmp_ge_u32 s2, 64
    s_cbranch_scc1 L_a_q1_ok
L_a_q1:
    ds_read_b32 v3, v0 offset:52
    s_waitcnt lgkmcnt(0)
    v_readfirstlane_b32 s27, v3
    s_cmp_ge_u32 s27, 4
    s_cbranch_scc1 L_a_q1_ok
    s_sleep 1
    s_branch L_a_q1
L_a_q1_ok:
    s_mov_b32 m0, s22
    s_add_u32 s22, s22, 4096
    buffer_load_dwordx4 v30, s[8:11], s23 offen sc1 lds
    s_add_u32 s23, s23, 4096
    s_mov_b32 m0, s22
    s_add_u32 s22, s22, 4096
    buffer_load_dwordx4 v30, s[8:11], s23 offen sc1 lds
    s_add_u32 s23, s23, 4096
    s_mov_b32 m0, s22
    s_add_u32 s22, s22, 4096
    buffer_load_dwordx4 v30, s[8:11], s23 offen sc1 lds
    s_add_u32 s23, s23, 4096
    s_mov_b32 m0, s22
    s_add_u32 s22, s22, 4096
    buffer_load_dwordx4 v30, s[8:11], s23 offen sc1 lds
    s_add_u32 s23, s23, 4096
    s_mov_b32 m0, s22
    s_add_u32 s22, s22, 4096
    buffer_load_dwordx4 v30, s[8:11], s23 offen sc1 lds
    s_add_u32 s23, s23, 4096
    s_mov_b32 m0, s22
    s_add_u32 s22, s22, 4096
    buffer_load_dwordx4 v30, s[8:11], s23 offen sc1 lds
    s_add_u32 s23, s23, 4096
    s_mov_b32 m0, s22
    s_add_u32 s22, s22, 4096
    buffer_load_dwordx4 v30, s[8:11], s23 offen sc1 lds
    s_add_u32 s23, s23, 4096
    s_mov_b32 m0, s22
    s_add_u32 s22, s22, 4096
    buffer_load_dwordx4 v30, s[8:11], s23 offen sc1 lds
    s_add_u32 s23, s23, 4096
    s_mov_b32 m0, s22
    s_add_u32 s22, s22, 4096
    buffer_load_dwordx4 v30, s[8:11], s23 offen sc1 lds
    s_add_u32 s23, s23, 4096
    s_mov_b32 m0, s22
    s_add_u32 s22, s22, 4096
    buffer_load_dwordx4 v30, s[8:11], s23 offen sc1 lds
    s_add_u32 s23, s23, 4096
    s_mov_b32 m0, s22
    s_add_u32 s22, s22, 4096
    buffer_load_dwordx4 v30, s[8:11], s23 offen sc1 lds
    s_add_u32 s23, s23, 4096
    s_mov_b32 m0, s22
    s_add_u32 s22, s22, 4096
    buffer_load_dwordx4 v30, s[8:11], s23 offen sc1 lds
    s_add_u32 s23, s23, 4096
    s_waitcnt vmcnt(5)
    s_mov_b64 exec, 1
    ds_add_u32 v0, v5 offset:12
    s_mov_b64 exec, -1
    s_cmp_lg_u32 s6, 0
    s_cbranch_scc1 L_a_kvn
    s_cmp_eq_u32 vcc_lo, 0
    s_cbranch_scc1 L_a_kvp2_ok
    s_mov_b32 s28, 0
L_a_kvp2:
    buffer_load_dwordx2 v[6:7], v9, s[8:11], s68 offen sc1
    s_add_u32 s28, s28, 1
    s_waitcnt vmcnt(0)
    v_cmp_ne_u32 vcc, s64, v6
    s_and_b32 s27, vcc_lo, 0xffffffff
    s_cbranch_scc0 L_a_kvp2_ok
    s_sleep 3
    s_cmp_lt_u32 s28, 131072
    s_cbranch_scc1 L_a_kvp2
L_a_kvp2_ok:
    s_nop 1
    v_max_f32_dpp v7, v7, v7 row_shr:1 row_mask:0xf bank_mask:0xf bound_ctrl:0
    s_nop 1
    v_max_f32_dpp v7, v7, v7 row_shr:2 row_mask:0xf bank_mask:0xf bound_ctrl:0
    s_nop 1
    v_max_f32_dpp v7, v7, v7 row_shr:4 row_mask:0xf bank_mask:0xf bound_ctrl:0
    s_nop 1
    v_max_f32_dpp v7, v7, v7 row_shr:8 row_mask:0xf bank_mask:0xf bound_ctrl:0
    s_nop 1
    v_readlane_b32 s32, v7, 15
    v_readlane_b32 s33, v7, 31
    s_nop 3
    s_max_u32 s32, s32, s33
    v_mov_b32 v7, s32
    ds_write_b32 v0, v7 offset:24
    s_waitcnt lgkmcnt(0)
    s_mov_b64 exec, 1
    ds_add_u32 v0, v5 offset:12
    s_mov_b64 exec, -1
L_a_kvn:
    s_waitcnt vmcnt(0)
    s_mov_b64 exec, 1
    ds_add_u32 v0, v5 offset:92
    s_mov_b64 exec, -1
    v_mov_b32 v40, -1
    v_mov_b32 v41, -1
    v_mov_b32 v42, -1
    v_mov_b32 v43, -1
    s_lshr_b32 s20, s3, 2
    s_and_b32 s21, s3, 3
    v_and_b32 v6, 31, v1
    v_mul_u32_u24 v6, 1280, v6
    v_lshrrev_b32 v7, 5, v1
    v_lshl_add_u32 v1, v7, 5, v6
    s_mul_i32 s38, s20, 40960
    s_mul_i32 s27, s21, 320
    s_add_u32 s38, s38, s27
L_a_ring:
    ds_read_b32 v3, v0 offset:48
    s_waitcnt lgkmcnt(0)
    v_readfirstlane_b32 s27, v3
    s_cmp_ge_u32 s27, s39
    s_cbranch_scc1 L_a_ring_ok
    s_sleep 2
    s_branch L_a_ring
L_a_ring_ok:
    s_setprio 3
L_a_ql0:
    ds_read_b32 v3, v0 offset:64
    s_waitcnt lgkmcnt(0)
    v_readfirstlane_b32 s27, v3
    s_cmp_ge_u32 s27, 8
    s_cbranch_scc1 L_a_ql0_ok
    s_sleep 1
    s_branch L_a_ql0
L_a_ql0_ok:
    s_setprio 0
    s_mov_b32 m0, s22
    s_add_u32 s22, s22, 4096
    buffer_load_dwordx4 v30, s[8:11], s23 offen sc1 lds
    s_add_u32 s23, s23, 4096
    s_waitcnt vmcnt(2)
    s_mov_b32 m0, s22
    s_add_u32 s22, s22, 4096
    buffer_load_dwordx4 v30, s[8:11], s23 offen sc1 lds
    s_add_u32 s23, s23, 4096
    s_waitcnt vmcnt(2)
    s_mov_b32 m0, s22
    s_add_u32 s22, s22, 4096
    buffer_load_dwordx4 v30, s[8:11], s23 offen sc1 lds
    s_add_u32 s23, s23, 4096
    s_waitcnt vmcnt(2)
    s_mov_b32 m0, s22
    s_add_u32 s22, s22, 4096
    buffer_load_dwordx4 v30, s[8:11], s23 offen sc1 lds
    s_add_u32 s23, s23, 4096
    s_waitcnt vmcnt(2)
    s_mov_b32 m0, s22
    s_add_u32 s22, s22, 4096
    buffer_load_dwordx4 v30, s[8:11], s23 offen sc1 lds
    s_add_u32 s23, s23, 4096
    s_waitcnt vmcnt(2)
    s_mov_b32 m0, s22
    s_add_u32 s22, s22, 4096
    buffer_load_dwordx4 v30, s[8:11], s23 offen sc1 lds
    s_add_u32 s23, s23, 4096
    s_waitcnt vmcnt(2)
    s_mov_b32 m0, s22
    s_add_u32 s22, s22, 4096
    buffer_load_dwordx4 v30, s[8:11], s23 offen sc1 lds
    s_add_u32 s23, s23, 4096
    s_waitcnt vmcnt(2)
    s_mov_b32 m0, s22
    s_add_u32 s22, s22, 4096
    buffer_load_dwordx4 v30, s[8:11], s23 offen sc1 lds
    s_add_u32 s23, s23, 4096
    s_waitcnt vmcnt(2)
    s_mov_b32 m0, s22
    s_add_u32 s22, s22, 4096
    buffer_load_dwordx4 v30, s[8:11], s23 offen sc1 lds
    s_add_u32 s23, s23, 4096
    s_waitcnt vmcnt(2)
    s_mov_b32 m0, s22
    s_add_u32 s22, s22, 4096
    buffer_load_dwordx4 v30, s[8:11], s23 offen sc1 lds
    s_add_u32 s23, s23, 4096
    s_waitcnt vmcnt(2)
    s_mov_b32 m0, s22
    s_add_u32 s22, s22, 4096
    buffer_load_dwordx4 v30, s[8:11], s23 offen sc1 lds
    s_add_u32 s23, s23, 4096
    s_waitcnt vmcnt(2)
    s_mov_b32 m0, s22
    s_add_u32 s22, s22, 4096
    buffer_load_dwordx4 v30, s[8:11], s23 offen sc1 lds
    s_add_u32 s23, s23, 4096
    s_waitcnt vmcnt(2)
    s_waitcnt vmcnt(6)
    s_mov_b64 exec, 1
    ds_add_u32 v0, v5 offset:32
    s_mov_b64 exec, -1
    s_mov_b32 m0, s22
    s_add_u32 s22, s22, 4096
    buffer_load_dwordx4 v30, s[8:11], s23 offen sc1 lds
    s_add_u32 s23, s23, 4096
    s_waitcnt vmcnt(2)
    s_mov_b32 m0, s22
    s_add_u32 s22, s22, 4096
    buffer_load_dwordx4 v30, s[8:11], s23 offen sc1 lds
    s_add_u32 s23, s23, 4096
    s_waitcnt vmcnt(2)
    s_mov_b32 m0, s22
    s_add_u32 s22, s22, 4096
    buffer_load_dwordx4 v30, s[8:11], s23 offen sc1 lds
    s_add_u32 s23, s23, 4096
    s_waitcnt vmcnt(2)
    s_mov_b32 m0, s22
    s_add_u32 s22, s22, 4096
    buffer_load_dwordx4 v30, s[8:11], s23 offen sc1 lds
    s_add_u32 s23, s23, 4096
    s_waitcnt vmcnt(2)
    s_mov_b32 m0, s22
    s_add_u32 s22, s22, 4096
    buffer_load_dwordx4 v30, s[8:11], s23 offen sc1 lds
    s_add_u32 s23, s23, 4096
    s_waitcnt vmcnt(2)
    s_mov_b32 m0, s22
    s_add_u32 s22, s22, 4096
    buffer_load_dwordx4 v30, s[8:11], s23 offen sc1 lds
    s_add_u32 s23, s23, 4096
    s_waitcnt vmcnt(2)
    s_mov_b32 m0, s22
    s_add_u32 s22, s22, 4096
    buffer_load_dwordx4 v30, s[8:11], s23 offen sc1 lds
    s_add_u32 s23, s23, 4096
    s_waitcnt vmcnt(2)
    s_mov_b32 m0, s22
    s_add_u32 s22, s22, 4096
    buffer_load_dwordx4 v30, s[8:11], s23 offen sc1 lds
    s_add_u32 s23, s23, 4096
    s_waitcnt vmcnt(2)
    s_mov_b32 m0, s22
    s_add_u32 s22, s22, 4096
    buffer_load_dwordx4 v30, s[8:11], s23 offen sc1 lds
    s_add_u32 s23, s23, 4096
    s_waitcnt vmcnt(2)
    s_mov_b32 m0, s22
    s_add_u32 s22, s22, 4096
    buffer_load_dwordx4 v30, s[8:11], s23 offen sc1 lds
    s_add_u32 s23, s23, 4096
    s_waitcnt vmcnt(2)
    s_mov_b32 m0, s22
    s_add_u32 s22, s22, 4096
    buffer_load_dwordx4 v30, s[8:11], s23 offen sc1 lds
    s_add_u32 s23, s23, 4096
    s_waitcnt vmcnt(2)
    s_mov_b32 m0, s22
    s_add_u32 s22, s22, 4096
    buffer_load_dwordx4 v30, s[8:11], s23 offen sc1 lds
    s_add_u32 s23, s23, 4096
    s_waitcnt vmcnt(2)
    s_mov_b32 m0, s22
    s_add_u32 s22, s22, 4096
    buffer_load_dwordx4 v30, s[8:11], s23 offen sc1 lds
    s_add_u32 s23, s23, 4096
    s_waitcnt vmcnt(2)
    s_mov_b32 m0, s22
    s_add_u32 s22, s22, 4096
    buffer_load_dwordx4 v30, s[8:11], s23 offen sc1 lds
    s_add_u32 s23, s23, 4096
    s_waitcnt vmcnt(2)
    s_mov_b32 m0, s22
    s_add_u32 s22, s22, 4096
    buffer_load_dwordx4 v30, s[8:11], s23 offen sc1 lds
    s_add_u32 s23, s23, 4096
    s_waitcnt vmcnt(2)
    s_cmp_eq_u32 s6, 3
    s_cselect_b32 exec_hi, 3, -1
    s_mov_b32 m0, s22
    s_add_u32 s22, s22, 4096
    buffer_load_dwordx4 v30, s[8:11], s23 offen sc1 lds
    s_add_u32 s23, s23, 4096
    s_waitcnt vmcnt(2)
    s_mov_b64 exec, -1
    s_waitcnt vmcnt(0)
    s_mov_b64 exec, 1
    ds_add_u32 v0, v5 offset:16
    s_mov_b64 exec, -1
    s_setprio 3
    s_lshr_b32 s30, s3, 2
    s_mul_i32 s30, s30, 136
    s_and_b32 s31, s3, 3
    s_lshl_b32 s32, s31, 3
    s_add_u32 s32, s32, s30
    s_lshl_b32 s33, s6, 1
    s_add_u32 s32, s32, s33
    s_lshl_b32 s32, s32, 10
    s_add_u32 s32, s32, 2621440
    buffer_store_dwordx4 v[40:43], v30, s[8:11], s32 offen sc1
    buffer_store_dwordx4 v[40:43], v30, s[8:11], s32 offen offset:1024 sc1
    s_lshl_b32 s32, s31, 1
    s_add_u32 s32, s32, s30
    s_and_b32 s33, s6, 1
    s_add_u32 s32, s32, s33
    s_lshl_b32 s32, s32, 10
    s_add_u32 s32, s32, 2654208
    buffer_store_dwordx4 v[40:43], v30, s[8:11], s32 offen sc1
    s_cmp_lg_u32 s6, 0
    s_cbranch_scc1 L_a_ff
    s_lshr_b32 s68, s3, 5
    s_and_b32 s31, s3, 3
    s_lshl_b32 s31, s31, 3
    s_add_u32 s68, s68, s31
    s_mul_i32 s68, s68, 4224
    s_add_u32 s68, s68, 15051776
    v_min_u32 v9, 45, v10
    v_lshlrev_b32 v9, 2, v9
    s_mov_b32 s28, 0
L_a_wp:
    buffer_load_dword v8, v9, s[8:11], s68 offen sc1
    s_add_u32 s28, s28, 1
    s_waitcnt vmcnt(0)
    v_cmp_ne_u32 vcc, s64, v8
    s_cbranch_vccz L_a_wp_ok
    s_sleep 12
    s_cmp_lt_u32 s28, 131072
    s_cbranch_scc1 L_a_wp
L_a_wp_ok:
    s_lshr_b32 s68, s3, 4
    s_mul_i32 s68, s68, 4224
    s_add_u32 s68, s68, 14713856
    v_min_u32 v9, 9, v10
    v_lshlrev_b32 v9, 2, v9
    s_mov_b32 s28, 0
L_a_hp:
    buffer_load_dword v8, v9, s[8:11], s68 offen sc1
    s_add_u32 s28, s28, 1
    s_waitcnt vmcnt(0)
    v_cmp_ne_u32 vcc, s64, v8
    s_cbranch_vccz L_a_hp_ok
    s_sleep 4
    s_cmp_lt_u32 s28, 131072
    s_cbranch_scc1 L_a_hp
L_a_hp_ok:
    s_mov_b64 exec, 1
    ds_add_u32 v0, v5 offset:56
    s_mov_b64 exec, -1
L_a_ff:
    ds_read_b32 v3, v0 offset:56
    s_waitcnt lgkmcnt(0)
    v_readfirstlane_b32 s27, v3
    s_cmp_ge_u32 s27, 1
    s_cbranch_scc1 L_a_ff_ok
    s_sleep 3
    s_branch L_a_ff
L_a_ff_ok:
    s_setprio 0
    s_mul_i32 s22, s6, 24
    s_add_u32 s22, s22, 40
    s_mul_i32 s33, s20, 136
    s_add_u32 s23, s33, s22
    s_lshl_b32 s23, s23, 10
    s_add_u32 s23, s23, 2621440
    s_mul_i32 s34, s21, 136
    s_add_u32 s24, s34, s22
    s_mul_i32 s24, s24, 5120
    s_add_u32 s24, s24, 11534336
    buffer_load_dwordx4 v[96:99], v2, s[8:11], s23 offen sc1
    buffer_load_dwordx4 v[100:103], v2, s[8:11], s24 offen offset:0 sc1
    buffer_load_dwordx4 v[104:107], v2, s[8:11], s24 offen offset:1024 sc1
    buffer_load_dwordx4 v[108:111], v2, s[8:11], s24 offen offset:2048 sc1
    buffer_load_dwordx4 v[112:115], v2, s[8:11], s24 offen offset:3072 sc1
    s_add_u32 s25, s24, 4096
    buffer_load_dwordx4 v[116:119], v2, s[8:11], s25 offen sc1
    s_add_u32 s23, s23, 1024
    s_add_u32 s24, s24, 5120
    buffer_load_dwordx4 v[120:123], v2, s[8:11], s23 offen sc1
    buffer_load_dwordx4 v[124:127], v2, s[8:11], s24 offen offset:0 sc1
    buffer_load_dwordx4 v[128:131], v2, s[8:11], s24 offen offset:1024 sc1
    buffer_load_dwordx4 v[132:135], v2, s[8:11], s24 offen offset:2048 sc1
    buffer_load_dwordx4 v[136:139], v2, s[8:11], s24 offen offset:3072 sc1
    s_add_u32 s25, s24, 4096
    buffer_load_dwordx4 v[140:143], v2, s[8:11], s25 offen sc1
    s_add_u32 s23, s23, 1024
    s_add_u32 s24, s24, 5120
    buffer_load_dwordx4 v[144:147], v2, s[8:11], s23 offen sc1
    buffer_load_dwordx4 v[148:151], v2, s[8:11], s24 offen offset:0 sc1
    buffer_load_dwordx4 v[152:155], v2, s[8:11], s24 offen offset:1024 sc1
    buffer_load_dwordx4 v[156:159], v2, s[8:11], s24 offen offset:2048 sc1
    buffer_load_dwordx4 v[160:163], v2, s[8:11], s24 offen offset:3072 sc1
    s_add_u32 s25, s24, 4096
    buffer_load_dwordx4 v[164:167], v2, s[8:11], s25 offen sc1
    s_add_u32 s23, s23, 1024
    s_add_u32 s24, s24, 5120
    s_mov_b32 s26, 7
    s_waitcnt vmcnt(12)
    v_mfma_f32_32x32x16_bf16 v[16:31], v[100:103], v[96:99], 0
    v_mfma_f32_32x32x16_bf16 v[32:47], v[104:107], v[96:99], 0
    v_mfma_f32_32x32x16_bf16 v[48:63], v[108:111], v[96:99], 0
    v_mfma_f32_32x32x16_bf16 v[64:79], v[112:115], v[96:99], 0
    v_mfma_f32_32x32x16_bf16 v[80:95], v[116:119], v[96:99], 0
    s_branch L_a_gin
L_a_gloop:
    s_waitcnt vmcnt(12)
    v_mfma_f32_32x32x16_bf16 v[16:31], v[100:103], v[96:99], v[16:31]
    v_mfma_f32_32x32x16_bf16 v[32:47], v[104:107], v[96:99], v[32:47]
    v_mfma_f32_32x32x16_bf16 v[48:63], v[108:111], v[96:99], v[48:63]
    v_mfma_f32_32x32x16_bf16 v[64:79], v[112:115], v[96:99], v[64:79]
    v_mfma_f32_32x32x16_bf16 v[80:95], v[116:119], v[96:99], v[80:95]
L_a_gin:
    buffer_load_dwordx4 v[96:99], v2, s[8:11], s23 offen sc1
    buffer_load_dwordx4 v[100:103], v2, s[8:11], s24 offen offset:0 sc1
    buffer_load_dwordx4 v[104:107], v2, s[8:11], s24 offen offset:1024 sc1
    buffer_load_dwordx4 v[108:111], v2, s[8:11], s24 offen offset:2048 sc1
    buffer_load_dwordx4 v[112:115], v2, s[8:11], s24 offen offset:3072 sc1
    s_add_u32 s25, s24, 4096
    buffer_load_dwordx4 v[116:119], v2, s[8:11], s25 offen sc1
    s_add_u32 s23, s23, 1024
    s_add_u32 s24, s24, 5120
    s_waitcnt vmcnt(12)
    v_mfma_f32_32x32x16_bf16 v[16:31], v[124:127], v[120:123], v[16:31]
    v_mfma_f32_32x32x16_bf16 v[32:47], v[128:131], v[120:123], v[32:47]
    v_mfma_f32_32x32x16_bf16 v[48:63], v[132:135], v[120:123], v[48:63]
    v_mfma_f32_32x32x16_bf16 v[64:79], v[136:139], v[120:123], v[64:79]
    v_mfma_f32_32x32x16_bf16 v[80:95], v[140:143], v[120:123], v[80:95]
    buffer_load_dwordx4 v[120:123], v2, s[8:11], s23 offen sc1
    buffer_load_dwordx4 v[124:127], v2, s[8:11], s24 offen offset:0 sc1
    buffer_load_dwordx4 v[128:131], v2, s[8:11], s24 offen offset:1024 sc1
    buffer_load_dwordx4 v[132:135], v2, s[8:11], s24 offen offset:2048 sc1
    buffer_load_dwordx4 v[136:139], v2, s[8:11], s24 offen offset:3072 sc1
    s_add_u32 s25, s24, 4096
    buffer_load_dwordx4 v[140:143], v2, s[8:11], s25 offen sc1
    s_add_u32 s23, s23, 1024
    s_add_u32 s24, s24, 5120
    s_waitcnt vmcnt(12)
    v_mfma_f32_32x32x16_bf16 v[16:31], v[148:151], v[144:147], v[16:31]
    v_mfma_f32_32x32x16_bf16 v[32:47], v[152:155], v[144:147], v[32:47]
    v_mfma_f32_32x32x16_bf16 v[48:63], v[156:159], v[144:147], v[48:63]
    v_mfma_f32_32x32x16_bf16 v[64:79], v[160:163], v[144:147], v[64:79]
    v_mfma_f32_32x32x16_bf16 v[80:95], v[164:167], v[144:147], v[80:95]
    buffer_load_dwordx4 v[144:147], v2, s[8:11], s23 offen sc1
    buffer_load_dwordx4 v[148:151], v2, s[8:11], s24 offen offset:0 sc1
    buffer_load_dwordx4 v[152:155], v2, s[8:11], s24 offen offset:1024 sc1
    buffer_load_dwordx4 v[156:159], v2, s[8:11], s24 offen offset:2048 sc1
    buffer_load_dwordx4 v[160:163], v2, s[8:11], s24 offen offset:3072 sc1
    s_add_u32 s25, s24, 4096
    buffer_load_dwordx4 v[164:167], v2, s[8:11], s25 offen sc1
    s_add_u32 s23, s23, 1024
    s_add_u32 s24, s24, 5120
    s_sub_u32 s26, s26, 1
    s_cmp_lg_u32 s26, 0
    s_cbranch_scc1 L_a_gloop
    s_waitcnt vmcnt(12)
    v_mfma_f32_32x32x16_bf16 v[16:31], v[100:103], v[96:99], v[16:31]
    v_mfma_f32_32x32x16_bf16 v[32:47], v[104:107], v[96:99], v[32:47]
    v_mfma_f32_32x32x16_bf16 v[48:63], v[108:111], v[96:99], v[48:63]
    v_mfma_f32_32x32x16_bf16 v[64:79], v[112:115], v[96:99], v[64:79]
    v_mfma_f32_32x32x16_bf16 v[80:95], v[116:119], v[96:99], v[80:95]
    s_waitcnt vmcnt(6)
    v_mfma_f32_32x32x16_bf16 v[16:31], v[124:127], v[120:123], v[16:31]
    v_mfma_f32_32x32x16_bf16 v[32:47], v[128:131], v[120:123], v[32:47]
    v_mfma_f32_32x32x16_bf16 v[48:63], v[132:135], v[120:123], v[48:63]
    v_mfma_f32_32x32x16_bf16 v[64:79], v[136:139], v[120:123], v[64:79]
    v_mfma_f32_32x32x16_bf16 v[80:95], v[140:143], v[120:123], v[80:95]
    s_waitcnt vmcnt(0)
    v_mfma_f32_32x32x16_bf16 v[16:31], v[148:151], v[144:147], v[16:31]
    v_mfma_f32_32x32x16_bf16 v[32:47], v[152:155], v[144:147], v[32:47]
    v_mfma_f32_32x32x16_bf16 v[48:63], v[156:159], v[144:147], v[48:63]
    v_mfma_f32_32x32x16_bf16 v[64:79], v[160:163], v[144:147], v[64:79]
    v_mfma_f32_32x32x16_bf16 v[80:95], v[164:167], v[144:147], v[80:95]
    s_setprio 3
    s_mov_b64 exec, 1
    ds_add_rtn_u32 v3, v0, v5 offset:40
    s_waitcnt lgkmcnt(0)
    v_readfirstlane_b32 s27, v3
    s_mov_b64 exec, -1
    s_cmp_lg_u32 s27, 3
    s_cbranch_scc1 L_a_noclr
    s_lshr_b32 s30, s3, 2
    s_mul_i32 s30, s30, 4224
    s_and_b32 s31, s3, 3
    s_lshl_b32 s31, s31, 2
    s_add_u32 s30, s30, s31
    s_add_u32 s30, s30, 14781440
    v_mul_u32_u24 v8, 4224, v10
    v_mov_b32 v9, s64
    s_mov_b32 exec_lo, 1
    s_mov_b32 exec_hi, 0
    buffer_store_dword v9, v8, s[8:11], s30 offen sc1
    s_mov_b64 exec, -1
L_a_noclr:
    s_mov_b32 s12, s44
    s_mov_b32 s13, s45
    s_mov_b32 s14, 2621440
    s_mov_b32 s15, 0x00020000
    s_mov_b32 s56, s60
    s_mov_b32 s57, s61
    s_mov_b32 s58, 2621440
    s_mov_b32 s59, 0x00020000
    s_lshl_b32 s39, s6, 6
    s_add_u32 s39, s39, s38
    s_lshl_b32 s27, s6, 3
    s_add_u32 s38, s38, s27
    s_add_u32 s38, s38, 256
    buffer_load_dwordx4 v[128:131], v1, s[12:15], s39 offen
    buffer_load_dwordx4 v[132:135], v1, s[12:15], s39 offen offset:16
    buffer_load_dwordx2 v[12:13], v1, s[12:15], s38 offen
    s_mul_i32 s35, s34, 5120
    s_lshl_b32 s37, s6, 10
    s_add_u32 s35, s35, s37
    s_add_u32 s35, s35, 11534336
    s_sub_u32 s36, 4096, s37
    v_add_u32 v4, s37, v2
    s_lshl_b32 s27, s6, 12
    v_add_u32 v6, s27, v2
    s_lshl_b32 s27, s6, 14
    v_add_u32 v7, s27, v2
    s_add_u32 s27, s6, 0
    s_and_b32 s27, s27, 3
    s_mul_i32 s40, s27, 40960
    s_add_u32 s40, s40, s35
    s_mul_i32 s46, s27, 10240
    s_add_u32 s46, s46, s35
    s_add_u32 s46, s46, 163840
    s_mul_i32 s27, s27, 10240
    s_add_u32 s27, s27, 118784
    v_add_u32 v11, s27, v2
    s_add_u32 s27, s6, 1
    s_and_b32 s27, s27, 3
    s_mul_i32 s41, s27, 40960
    s_add_u32 s41, s41, s35
    s_mul_i32 s47, s27, 10240
    s_add_u32 s47, s47, s35
    s_add_u32 s47, s47, 163840
    s_mul_i32 s27, s27, 10240
    s_add_u32 s27, s27, 118784
    v_add_u32 v14, s27, v2
    s_add_u32 s27, s6, 2
    s_and_b32 s27, s27, 3
    s_mul_i32 s42, s27, 40960
    s_add_u32 s42, s42, s35
    s_mul_i32 s48, s27, 10240
    s_add_u32 s48, s48, s35
    s_add_u32 s48, s48, 163840
    s_mul_i32 s27, s27, 10240
    s_add_u32 s27, s27, 118784
    v_add_u32 v15, s27, v2
    s_add_u32 s27, s6, 3
    s_and_b32 s27, s27, 3
    s_mul_i32 s43, s27, 40960
    s_add_u32 s43, s43, s35
    s_mul_i32 s49, s27, 10240
    s_add_u32 s49, s49, s35
    s_add_u32 s49, s49, 163840
    s_mul_i32 s27, s27, 10240
    s_add_u32 s27, s27, 118784
    v_add_u32 v8, s27, v2
    s_lshl_b32 s27, s6, 3
    s_add_u32 s50, s33, s27
    s_lshl_b32 s50, s50, 10
    s_add_u32 s50, s50, 2621440
    s_add_u32 s23, s50, 4096
    s_lshl_b32 s27, s6, 1
    s_add_u32 s51, s33, s27
    s_lshl_b32 s51, s51, 10
    s_add_u32 s51, s51, 2654208
    s_setprio 0
    s_add_u32 s25, s40, 10240
    buffer_load_dwordx4 v[96:99], v2, s[8:11], s25 offen sc1
    s_add_u32 s25, s40, 15360
    buffer_load_dwordx4 v[100:103], v2, s[8:11], s25 offen sc1
    s_add_u32 s25, s40, 20480
    buffer_load_dwordx4 v[104:107], v2, s[8:11], s25 offen sc1
    s_add_u32 s25, s40, 25600
    buffer_load_dwordx4 v[108:111], v2, s[8:11], s25 offen sc1
    s_add_u32 s25, s40, 30720
    buffer_load_dwordx4 v[112:115], v2, s[8:11], s25 offen sc1
    s_add_u32 s25, s40, 35840
    buffer_load_dwordx4 v[116:119], v2, s[8:11], s25 offen sc1
    s_add_u32 s25, s46, 0
    buffer_load_dwordx4 v[120:123], v2, s[8:11], s25 offen sc1
    s_add_u32 s25, s46, 5120
    buffer_load_dwordx4 v[124:127], v2, s[8:11], s25 offen sc1
    s_setprio 3
L_t_p32:
    ds_read_b32 v3, v0 offset:0
    s_waitcnt lgkmcnt(0)
    v_readfirstlane_b32 s27, v3
    s_cmp_ge_u32 s27, 8
    s_cbranch_scc1 L_t_p32_ok
    s_sleep 16
    s_branch L_t_p32
L_t_p32_ok:
    s_setprio 0
    s_add_u32 s25, s42, 30720
    s_add_u32 m0, s37, 65536
    s_nop 0
    buffer_load_dwordx4 v2, s[8:11], s25 offen sc1 lds
    s_add_u32 s25, s42, 35840
    s_add_u32 m0, s37, 69632
    s_nop 0
    buffer_load_dwordx4 v2, s[8:11], s25 offen sc1 lds
    s_add_u32 s25, s48, 0
    s_add_u32 m0, s37, 73728
    s_nop 0
    buffer_load_dwordx4 v2, s[8:11], s25 offen sc1 lds
    s_add_u32 s25, s48, 5120
    s_add_u32 m0, s37, 77824
    s_nop 0
    buffer_load_dwordx4 v2, s[8:11], s25 offen sc1 lds
    ds_write_b128 v6, v[16:19] offset:0
    ds_write_b128 v6, v[20:23] offset:1024
    ds_write_b128 v6, v[24:27] offset:2048
    ds_write_b128 v6, v[28:31] offset:3072
    ds_write_b128 v6, v[32:35] offset:16384
    ds_write_b128 v6, v[36:39] offset:17408
    ds_write_b128 v6, v[40:43] offset:18432
    ds_write_b128 v6, v[44:47] offset:19456
    ds_write_b128 v6, v[48:51] offset:32768
    ds_write_b128 v6, v[52:55] offset:33792
    ds_write_b128 v6, v[56:59] offset:34816
    ds_write_b128 v6, v[60:63] offset:35840
    ds_write_b128 v6, v[64:67] offset:49152
    ds_write_b128 v6, v[68:71] offset:50176
    ds_write_b128 v6, v[72:75] offset:51200
    ds_write_b128 v6, v[76:79] offset:52224
    s_waitcnt lgkmcnt(0)
    s_mov_b64 exec, 1
    ds_add_u32 v0, v5 offset:68
    s_mov_b64 exec, -1
    s_setprio 3
    v_mov_b32 v6, v8
L_t_red:
    ds_read_b32 v3, v0 offset:68
    s_waitcnt lgkmcnt(0)
    v_readfirstlane_b32 s27, v3
    s_cmp_ge_u32 s27, 4
    s_cbranch_scc1 L_t_red_ok
    s_sleep 4
    s_branch L_t_red
L_t_red_ok:
    ds_read_b128 v[16:19], v7 offset:0
    ds_read_b128 v[20:23], v7 offset:1024
    ds_read_b128 v[24:27], v7 offset:2048
    ds_read_b128 v[28:31], v7 offset:3072
    ds_read_b128 v[32:35], v7 offset:4096
    ds_read_b128 v[36:39], v7 offset:5120
    ds_read_b128 v[40:43], v7 offset:6144
    ds_read_b128 v[44:47], v7 offset:7168
    ds_read_b128 v[48:51], v7 offset:8192
    ds_read_b128 v[52:55], v7 offset:9216
    ds_read_b128 v[56:59], v7 offset:10240
    ds_read_b128 v[60:63], v7 offset:11264
    s_waitcnt lgkmcnt(4)
    ds_read_b128 v[64:67], v7 offset:12288
    ds_read_b128 v[68:71], v7 offset:13312
    ds_read_b128 v[72:75], v7 offset:14336
    ds_read_b128 v[76:79], v7 offset:15360
    s_waitcnt lgkmcnt(0)
    s_mov_b64 exec, 1
    ds_add_u32 v0, v5 offset:72
    s_mov_b64 exec, -1
L_t_red2:
    ds_read_b32 v3, v0 offset:72
    s_waitcnt lgkmcnt(0)
    v_readfirstlane_b32 s27, v3
    s_cmp_ge_u32 s27, 4
    s_cbranch_scc1 L_t_red2_ok
    s_sleep 2
    s_branch L_t_red2
L_t_red2_ok:
    s_setprio 0
    s_add_u32 s25, s41, 0
    s_add_u32 m0, s37, 0
    s_nop 0
    buffer_load_dwordx4 v2, s[8:11], s25 offen sc1 lds
    s_add_u32 s25, s41, 5120
    s_add_u32 m0, s37, 4096
    s_nop 0
    buffer_load_dwordx4 v2, s[8:11], s25 offen sc1 lds
    s_add_u32 s25, s41, 10240
    s_add_u32 m0, s37, 8192
    s_nop 0
    buffer_load_dwordx4 v2, s[8:11], s25 offen sc1 lds
    s_add_u32 s25, s41, 15360
    s_add_u32 m0, s37, 12288
    s_nop 0
    buffer_load_dwordx4 v2, s[8:11], s25 offen sc1 lds
    s_add_u32 s25, s41, 20480
    s_add_u32 m0, s37, 16384
    s_nop 0
    buffer_load_dwordx4 v2, s[8:11], s25 offen sc1 lds
    s_add_u32 s25, s41, 25600
    s_add_u32 m0, s37, 20480
    s_nop 0
    buffer_load_dwordx4 v2, s[8:11], s25 offen sc1 lds
    s_add_u32 s25, s41, 30720
    s_add_u32 m0, s37, 24576
    s_nop 0
    buffer_load_dwordx4 v2, s[8:11], s25 offen sc1 lds
    s_add_u32 s25, s41, 35840
    s_add_u32 m0, s37, 28672
    s_nop 0
    buffer_load_dwordx4 v2, s[8:11], s25 offen sc1 lds
    s_add_u32 s25, s47, 0
    s_add_u32 m0, s37, 32768
    s_nop 0
    buffer_load_dwordx4 v2, s[8:11], s25 offen sc1 lds
    s_add_u32 s25, s47, 5120
    s_add_u32 m0, s37, 36864
    s_nop 0
    buffer_load_dwordx4 v2, s[8:11], s25 offen sc1 lds
    s_add_u32 s25, s42, 0
    s_add_u32 m0, s37, 40960
    s_nop 0
    buffer_load_dwordx4 v2, s[8:11], s25 offen sc1 lds
    s_add_u32 s25, s42, 5120
    s_add_u32 m0, s37, 45056
    s_nop 0
    buffer_load_dwordx4 v2, s[8:11], s25 offen sc1 lds
    s_add_u32 s25, s42, 10240
    s_add_u32 m0, s37, 49152
    s_nop 0
    buffer_load_dwordx4 v2, s[8:11], s25 offen sc1 lds
    s_add_u32 s25, s42, 15360
    s_add_u32 m0, s37, 53248
    s_nop 0
    buffer_load_dwordx4 v2, s[8:11], s25 offen sc1 lds
    s_add_u32 s25, s42, 20480
    s_add_u32 m0, s37, 57344
    s_nop 0
    buffer_load_dwordx4 v2, s[8:11], s25 offen sc1 lds
    s_add_u32 s25, s42, 25600
    s_add_u32 m0, s37, 61440
    s_nop 0
    buffer_load_dwordx4 v2, s[8:11], s25 offen sc1 lds
    s_setprio 3
    v_add_f32 v16, v16, v32
    v_add_f32 v17, v17, v33
    v_add_f32 v18, v18, v34
    v_add_f32 v19, v19, v35
    v_add_f32 v20, v20, v36
    v_add_f32 v21, v21, v37
    v_add_f32 v22, v22, v38
    v_add_f32 v23, v23, v39
    v_add_f32 v24, v24, v40
    v_add_f32 v25, v25, v41
    v_add_f32 v26, v26, v42
    v_add_f32 v27, v27, v43
    v_add_f32 v28, v28, v44
    v_add_f32 v29, v29, v45
    v_add_f32 v30, v30, v46
    v_add_f32 v31, v31, v47
    v_add_f32 v16, v16, v48
    v_add_f32 v17, v17, v49
    v_add_f32 v18, v18, v50
    v_add_f32 v19, v19, v51
    v_add_f32 v20, v20, v52
    v_add_f32 v21, v21, v53
    v_add_f32 v22, v22, v54
    v_add_f32 v23, v23, v55
    v_add_f32 v24, v24, v56
    v_add_f32 v25, v25, v57
    v_add_f32 v26, v26, v58
    v_add_f32 v27, v27, v59
    v_add_f32 v28, v28, v60
    v_add_f32 v29, v29, v61
    v_add_f32 v30, v30, v62
    v_add_f32 v31, v31, v63
    v_add_f32 v16, v16, v64
    v_add_f32 v17, v17, v65
    v_add_f32 v18, v18, v66
    v_add_f32 v19, v19, v67
    v_add_f32 v20, v20, v68
    v_add_f32 v21, v21, v69
    v_add_f32 v22, v22, v70
    v_add_f32 v23, v23, v71
    v_add_f32 v24, v24, v72
    v_add_f32 v25, v25, v73
    v_add_f32 v26, v26, v74
    v_add_f32 v27, v27, v75
    v_add_f32 v28, v28, v76
    v_add_f32 v29, v29, v77
    v_add_f32 v30, v30, v78
    v_add_f32 v31, v31, v79
    s_waitcnt vmcnt(28)
    v_lshlrev_b32 v32, 16, v128
    v_and_b32 v33, 0xffff0000, v128
    v_lshlrev_b32 v34, 16, v129
    v_and_b32 v35, 0xffff0000, v129
    v_lshlrev_b32 v36, 16, v130
    v_and_b32 v37, 0xffff0000, v130
    v_lshlrev_b32 v38, 16, v131
    v_and_b32 v39, 0xffff0000, v131
    v_lshlrev_b32 v40, 16, v132
    v_and_b32 v41, 0xffff0000, v132
    v_lshlrev_b32 v42, 16, v133
    v_and_b32 v43, 0xffff0000, v133
    v_lshlrev_b32 v44, 16, v134
    v_and_b32 v45, 0xffff0000, v134
    v_lshlrev_b32 v46, 16, v135
    v_and_b32 v47, 0xffff0000, v135
    v_add_f32 v16, v16, v32
    v_add_f32 v17, v17, v33
    v_add_f32 v18, v18, v34
    v_add_f32 v19, v19, v35
    v_add_f32 v20, v20, v36
    v_add_f32 v21, v21, v37
    v_add_f32 v22, v22, v38
    v_add_f32 v23, v23, v39
    v_add_f32 v24, v24, v40
    v_add_f32 v25, v25, v41
    v_add_f32 v26, v26, v42
    v_add_f32 v27, v27, v43
    v_add_f32 v28, v28, v44
    v_add_f32 v29, v29, v45
    v_add_f32 v30, v30, v46
    v_add_f32 v31, v31, v47
    s_setprio 0
    s_add_u32 s25, s40, 0
    s_add_u32 s25, s25, s36
    buffer_load_dwordx4 v[32:35], v2, s[8:11], s25 offen sc1
    s_add_u32 s25, s40, 5120
    s_add_u32 s25, s25, s36
    buffer_load_dwordx4 v[36:39], v2, s[8:11], s25 offen sc1
    s_add_u32 s25, s40, 10240
    s_add_u32 s25, s25, s36
    buffer_load_dwordx4 v[40:43], v2, s[8:11], s25 offen sc1
    s_add_u32 s25, s40, 15360
    s_add_u32 s25, s25, s36
    buffer_load_dwordx4 v[44:47], v2, s[8:11], s25 offen sc1
    s_add_u32 s25, s40, 20480
    s_add_u32 s25, s25, s36
    buffer_load_dwordx4 v[48:51], v2, s[8:11], s25 offen sc1
    s_add_u32 s25, s40, 25600
    s_add_u32 s25, s25, s36
    buffer_load_dwordx4 v[52:55], v2, s[8:11], s25 offen sc1
    s_add_u32 s25, s40, 30720
    s_add_u32 s25, s25, s36
    buffer_load_dwordx4 v[56:59], v2, s[8:11], s25 offen sc1
    s_add_u32 s25, s40, 35840
    s_add_u32 s25, s25, s36
    buffer_load_dwordx4 v[60:63], v2, s[8:11], s25 offen sc1
    s_add_u32 s25, s46, 0
    s_add_u32 s25, s25, s36
    buffer_load_dwordx4 v[64:67], v2, s[8:11], s25 offen sc1
    s_add_u32 s25, s46, 5120
    s_add_u32 s25, s25, s36
    buffer_load_dwordx4 v[68:71], v2, s[8:11], s25 offen sc1
    s_add_u32 s25, s40, 0
    buffer_load_dwordx4 v[72:75], v2, s[8:11], s25 offen sc1
    s_add_u32 s25, s40, 5120
    buffer_load_dwordx4 v[76:79], v2, s[8:11], s25 offen sc1
    s_setprio 3
    s_lshr_b32 s68, s3, 2
    s_mul_i32 s68, s68, 4224
    s_add_u32 s68, s68, 14781440
    v_min_u32 v9, 3, v10
    v_lshlrev_b32 v9, 2, v9
    s_mov_b32 s28, 0
L_a_cp:
    buffer_load_dword v8, v9, s[8:11], s68 offen sc1
    s_add_u32 s28, s28, 1
    s_waitcnt vmcnt(0)
    v_cmp_ne_u32 vcc, s64, v8
    s_cbranch_vccz L_a_cp_ok
    s_sleep 8
    s_cmp_lt_u32 s28, 131072
    s_cbranch_scc1 L_a_cp
L_a_cp_ok:
    s_and_b32 s29, s3, 0xfc
    s_add_u32 s29, s29, s6
    s_lshr_b32 s30, s29, 2
    s_mul_i32 s30, s30, 4224
    s_and_b32 s31, s29, 3
    s_lshl_b32 s31, s31, 3
    s_add_u32 s30, s30, s31
    s_add_u32 s30, s30, 14781440
    buffer_load_dwordx2 v[8:9], off, s[8:11], s30 offset:64 sc1
    s_waitcnt vmcnt(0)
    v_readfirstlane_b32 s30, v8
    v_readfirstlane_b32 s31, v9
    s_nop 1
    s_xor_b32 s30, s30, s64
    s_xor_b32 s31, s31, s54
    s_or_b32 s55, s30, s31
L_t_p48:
    ds_read_b32 v3, v0 offset:4
    s_waitcnt lgkmcnt(0)
    v_readfirstlane_b32 s27, v3
    s_cmp_ge_u32 s27, 8
    s_cbranch_scc1 L_t_p48_ok
    s_sleep 16
    s_branch L_t_p48
L_t_p48_ok:
    s_setprio 0
    s_add_u32 s25, s43, 0
    s_add_u32 m0, s37, 81920
    s_nop 0
    buffer_load_dwordx4 v2, s[8:11], s25 offen sc1 lds
    s_add_u32 s25, s43, 5120
    s_add_u32 m0, s37, 86016
    s_nop 0
    buffer_load_dwordx4 v2, s[8:11], s25 offen sc1 lds
    s_add_u32 s25, s43, 10240
    s_add_u32 m0, s37, 90112
    s_nop 0
    buffer_load_dwordx4 v2, s[8:11], s25 offen sc1 lds
    s_add_u32 s25, s43, 15360
    s_add_u32 m0, s37, 94208
    s_nop 0
    buffer_load_dwordx4 v2, s[8:11], s25 offen sc1 lds
    s_add_u32 s25, s43, 20480
    s_add_u32 m0, s37, 98304
    s_nop 0
    buffer_load_dwordx4 v2, s[8:11], s25 offen sc1 lds
    s_add_u32 s25, s43, 25600
    s_add_u32 m0, s37, 102400
    s_nop 0
    buffer_load_dwordx4 v2, s[8:11], s25 offen sc1 lds
    s_add_u32 s25, s43, 30720
    s_add_u32 m0, s37, 106496
    s_nop 0
    buffer_load_dwordx4 v2, s[8:11], s25 offen sc1 lds
    s_add_u32 s25, s43, 35840
    s_add_u32 m0, s37, 110592
    s_nop 0
    buffer_load_dwordx4 v2, s[8:11], s25 offen sc1 lds
    s_add_u32 s25, s49, 0
    s_add_u32 m0, s37, 114688
    s_nop 0
    buffer_load_dwordx4 v2, s[8:11], s25 offen sc1 lds
    s_setprio 3
    s_lshr_b32 s30, s3, 2
    s_mul_i32 s30, s30, 4224
    s_add_u32 s30, s30, 14781440
    s_lshl_b32 s31, s6, 7
    s_add_u32 s30, s30, s31
    s_add_u32 s30, s30, 640
    v_and_b32 v9, 7, v10
    v_lshl_add_u32 v9, v9, 2, s30
    v_add_u32 v7, 0x10000, v4
    s_lshl_b32 s27, s6, 12
    v_add_u32 v10, s27, v2
    s_setprio 3
L_t_rel:
    ds_read_b32 v3, v0 offset:8
    s_waitcnt lgkmcnt(0)
    v_readfirstlane_b32 s27, v3
    s_cmp_ge_u32 s27, 8
    s_cbranch_scc1 L_t_rel_ok
    s_sleep 6
    s_branch L_t_rel
L_t_rel_ok:
    s_cmp_lg_u32 s55, 0
    s_cbranch_scc1 L_t_hint
L_t_fin:
    ds_read_b32 v3, v0 offset:80
    s_waitcnt lgkmcnt(0)
    v_readfirstlane_b32 s27, v3
    s_cmp_ge_u32 s27, 8
    s_cbranch_scc1 L_t_fin_ok
    s_sleep 1
    s_branch L_t_fin
L_t_fin_ok:
    s_branch L_t_oh_ok
L_t_hint:
    s_mov_b32 s68, 0
    s_mov_b32 s28, 0
L_t_oh:
    s_cmp_eq_u32 s55, 0
    s_cbranch_scc1 L_t_oh_t_l
    buffer_load_dword v8, v9, s[8:11], s68 offen sc1
    s_branch L_t_oh_t_e
L_t_oh_t_l:
    buffer_load_dword v8, v9, s[8:11], s68 offen nt
L_t_oh_t_e:
    s_add_u32 s28, s28, 1
    s_waitcnt vmcnt(0)
    v_cmp_ne_u32 vcc, s64, v8
    s_cbranch_vccz L_t_oh_ok
    s_sleep 0
    s_cmp_lt_u32 s28, 131072
    s_cbranch_scc1 L_t_oh
L_t_oh_ok:
    s_mov_b32 s28, 0
L_t_op:
    s_cmp_eq_u32 s55, 0
    s_cbranch_scc1 L_t_ol_l
    buffer_load_dwordx4 v[128:131], v2, s[8:11], s50 offen offset:0 sc1
    buffer_load_dwordx4 v[132:135], v2, s[8:11], s50 offen offset:1024 sc1
    buffer_load_dwordx4 v[136:139], v2, s[8:11], s50 offen offset:2048 sc1
    buffer_load_dwordx4 v[140:143], v2, s[8:11], s50 offen offset:3072 sc1
    buffer_load_dwordx4 v[144:147], v2, s[8:11], s23 offen offset:0 sc1
    buffer_load_dwordx4 v[148:151], v2, s[8:11], s23 offen offset:1024 sc1
    buffer_load_dwordx4 v[152:155], v2, s[8:11], s23 offen offset:2048 sc1
    buffer_load_dwordx4 v[156:159], v2, s[8:11], s23 offen offset:3072 sc1
    buffer_load_dwordx4 v[160:163], v2, s[8:11], s51 offen offset:0 sc1
    buffer_load_dwordx4 v[164:167], v2, s[8:11], s51 offen offset:1024 sc1
    s_branch L_t_ol_e
L_t_ol_l:
    buffer_load_dwordx4 v[128:131], v2, s[8:11], s50 offen offset:0 nt
    buffer_load_dwordx4 v[132:135], v2, s[8:11], s50 offen offset:1024 nt
    buffer_load_dwordx4 v[136:139], v2, s[8:11], s50 offen offset:2048 nt
    buffer_load_dwordx4 v[140:143], v2, s[8:11], s50 offen offset:3072 nt
    buffer_load_dwordx4 v[144:147], v2, s[8:11], s23 offen offset:0 nt
    buffer_load_dwordx4 v[148:151], v2, s[8:11], s23 offen offset:1024 nt
    buffer_load_dwordx4 v[152:155], v2, s[8:11], s23 offen offset:2048 nt
    buffer_load_dwordx4 v[156:159], v2, s[8:11], s23 offen offset:3072 nt
    buffer_load_dwordx4 v[160:163], v2, s[8:11], s51 offen offset:0 nt
    buffer_load_dwordx4 v[164:167], v2, s[8:11], s51 offen offset:1024 nt
L_t_ol_e:
    s_waitcnt vmcnt(9)
    ds_write_b128 v11, v[128:131] offset:0
    v_max3_u32 v3, v128, v129, v130
    v_max_u32 v3, v3, v131
    s_waitcnt vmcnt(8)
    ds_write_b128 v11, v[132:135] offset:1024
    v_max3_u32 v3, v3, v132, v133
    v_max3_u32 v3, v3, v134, v135
    s_waitcnt vmcnt(7)
    ds_write_b128 v11, v[136:139] offset:2048
    v_max3_u32 v3, v3, v136, v137
    v_max3_u32 v3, v3, v138, v139
    s_waitcnt vmcnt(6)
    ds_write_b128 v11, v[140:143] offset:3072
    v_max3_u32 v3, v3, v140, v141
    v_max3_u32 v3, v3, v142, v143
    s_waitcnt vmcnt(5)
    ds_write_b128 v11, v[144:147] offset:4096
    v_max3_u32 v3, v3, v144, v145
    v_max3_u32 v3, v3, v146, v147
    s_waitcnt vmcnt(4)
    ds_write_b128 v11, v[148:151] offset:5120
    v_max3_u32 v3, v3, v148, v149
    v_max3_u32 v3, v3, v150, v151
    s_waitcnt vmcnt(3)
    ds_write_b128 v11, v[152:155] offset:6144
    v_max3_u32 v3, v3, v152, v153
    v_max3_u32 v3, v3, v154, v155
    s_waitcnt vmcnt(2)
    ds_write_b128 v11, v[156:159] offset:7168
    v_max3_u32 v3, v3, v156, v157
    v_max3_u32 v3, v3, v158, v159
    s_waitcnt vmcnt(1)
    ds_write_b128 v11, v[160:163] offset:8192
    v_max3_u32 v3, v3, v160, v161
    v_max3_u32 v3, v3, v162, v163
    s_waitcnt vmcnt(0)
    ds_write_b128 v11, v[164:167] offset:9216
    v_max3_u32 v3, v3, v164, v165
    v_max3_u32 v3, v3, v166, v167
    v_cmp_eq_u32 vcc, -1, v3
    s_waitcnt lgkmcnt(0)
    s_cbranch_vccz L_t_ok
    s_add_u32 s28, s28, 1
    s_cmp_lt_u32 s28, 131072
    s_cbranch_scc1 L_t_op
L_t_ok:
    s_mov_b64 exec, 1
    ds_add_u32 v0, v5 offset:76
    s_mov_b64 exec, -1
    v_mfma_f32_32x32x16_bf16 v[80:95], v[32:35], v[128:131], v[80:95]
    s_add_u32 s25, s49, 5120
    buffer_load_dwordx4 v[32:35], v2, s[8:11], s25 offen sc1
    v_mfma_f32_32x32x16_bf16 v[80:95], v[36:39], v[132:135], v[80:95]
    ds_read_b128 v[36:39], v4 offset:0
    v_mfma_f32_32x32x16_bf16 v[80:95], v[40:43], v[136:139], v[80:95]
    ds_read_b128 v[40:43], v4 offset:4096
    v_mfma_f32_32x32x16_bf16 v[80:95], v[44:47], v[140:143], v[80:95]
    ds_read_b128 v[44:47], v4 offset:8192
    v_mfma_f32_32x32x16_bf16 v[80:95], v[48:51], v[144:147], v[80:95]
    ds_read_b128 v[48:51], v4 offset:12288
    v_mfma_f32_32x32x16_bf16 v[80:95], v[52:55], v[148:151], v[80:95]
    ds_read_b128 v[52:55], v4 offset:16384
    v_mfma_f32_32x32x16_bf16 v[80:95], v[56:59], v[152:155], v[80:95]
    ds_read_b128 v[56:59], v4 offset:20480
    v_mfma_f32_32x32x16_bf16 v[80:95], v[60:63], v[156:159], v[80:95]
    ds_read_b128 v[60:63], v4 offset:24576
    v_mfma_f32_32x32x16_bf16 v[80:95], v[64:67], v[160:163], v[80:95]
    ds_read_b128 v[64:67], v4 offset:28672
    v_mfma_f32_32x32x16_bf16 v[80:95], v[68:71], v[164:167], v[80:95]
    ds_read_b128 v[68:71], v4 offset:32768
    v_mfma_f32_32x32x16_bf16 v[16:31], v[72:75], v[128:131], v[16:31]
    ds_read_b128 v[72:75], v4 offset:36864
    v_mfma_f32_32x32x16_bf16 v[16:31], v[76:79], v[132:135], v[16:31]
    ds_read_b128 v[76:79], v4 offset:40960
    v_mfma_f32_32x32x16_bf16 v[16:31], v[96:99], v[136:139], v[16:31]
    ds_read_b128 v[96:99], v4 offset:45056
    v_mfma_f32_32x32x16_bf16 v[16:31], v[100:103], v[140:143], v[16:31]
    ds_read_b128 v[100:103], v4 offset:49152
    v_mfma_f32_32x32x16_bf16 v[16:31], v[104:107], v[144:147], v[16:31]
    ds_read_b128 v[104:107], v4 offset:53248
    v_mfma_f32_32x32x16_bf16 v[16:31], v[108:111], v[148:151], v[16:31]
    v_mfma_f32_32x32x16_bf16 v[16:31], v[112:115], v[152:155], v[16:31]
    s_waitcnt lgkmcnt(0)
    ds_write_b128 v4, v[80:83] offset:0
    ds_write_b128 v4, v[84:87] offset:4096
    ds_write_b128 v4, v[88:91] offset:8192
    ds_write_b128 v4, v[92:95] offset:12288
    v_mfma_f32_32x32x16_bf16 v[16:31], v[116:119], v[156:159], v[16:31]
    v_mfma_f32_32x32x16_bf16 v[16:31], v[120:123], v[160:163], v[16:31]
    v_mfma_f32_32x32x16_bf16 v[16:31], v[124:127], v[164:167], v[16:31]
    s_waitcnt lgkmcnt(0)
    s_mov_b64 exec, 1
    ds_add_u32 v0, v5 offset:84
    s_mov_b64 exec, -1
L_t_o:
    ds_read_b32 v3, v0 offset:76
    s_waitcnt lgkmcnt(0)
    v_readfirstlane_b32 s27, v3
    s_cmp_ge_u32 s27, 4
    s_cbranch_scc1 L_t_o_ok
    s_sleep 0
    s_branch L_t_o
L_t_o_ok:
    ds_read_b128 v[128:131], v14 offset:0
    ds_read_b128 v[132:135], v14 offset:1024
    ds_read_b128 v[136:139], v14 offset:2048
    ds_read_b128 v[140:143], v14 offset:3072
    ds_read_b128 v[144:147], v14 offset:4096
    ds_read_b128 v[148:151], v14 offset:5120
    ds_read_b128 v[152:155], v14 offset:6144
    ds_read_b128 v[156:159], v14 offset:7168
    ds_read_b128 v[108:111], v4 offset:57344
    ds_read_b128 v[112:115], v4 offset:61440
    s_waitcnt lgkmcnt(9)
    v_mfma_f32_32x32x16_bf16 v[16:31], v[36:39], v[128:131], v[16:31]
    ds_read_b128 v[160:163], v14 offset:8192
    s_waitcnt lgkmcnt(9)
    v_mfma_f32_32x32x16_bf16 v[16:31], v[40:43], v[132:135], v[16:31]
    ds_read_b128 v[164:167], v14 offset:9216
    s_waitcnt lgkmcnt(9)
    v_mfma_f32_32x32x16_bf16 v[16:31], v[44:47], v[136:139], v[16:31]
    ds_read_b128 v[128:131], v15 offset:0
    s_waitcnt lgkmcnt(9)
    v_mfma_f32_32x32x16_bf16 v[16:31], v[48:51], v[140:143], v[16:31]
    ds_read_b128 v[132:135], v15 offset:1024
    s_waitcnt lgkmcnt(9)
    v_mfma_f32_32x32x16_bf16 v[16:31], v[52:55], v[144:147], v[16:31]
    ds_read_b128 v[136:139], v15 offset:2048
    s_waitcnt lgkmcnt(9)
    v_mfma_f32_32x32x16_bf16 v[16:31], v[56:59], v[148:151], v[16:31]
    ds_read_b128 v[140:143], v15 offset:3072
    s_waitcnt lgkmcnt(9)
    v_mfma_f32_32x32x16_bf16 v[16:31], v[60:63], v[152:155], v[16:31]
    ds_read_b128 v[144:147], v15 offset:4096
    s_waitcnt lgkmcnt(9)
    v_mfma_f32_32x32x16_bf16 v[16:31], v[64:67], v[156:159], v[16:31]
    ds_read_b128 v[148:151], v15 offset:5120
    s_waitcnt lgkmcnt(7)
    v_mfma_f32_32x32x16_bf16 v[16:31], v[68:71], v[160:163], v[16:31]
    ds_read_b128 v[152:155], v15 offset:6144
    s_waitcnt lgkmcnt(7)
    v_mfma_f32_32x32x16_bf16 v[16:31], v[72:75], v[164:167], v[16:31]
    ds_read_b128 v[156:159], v15 offset:7168
    s_waitcnt lgkmcnt(7)
    v_mfma_f32_32x32x16_bf16 v[16:31], v[76:79], v[128:131], v[16:31]
    ds_read_b128 v[160:163], v15 offset:8192
    ds_read_b128 v[36:39], v7 offset:0
    s_waitcnt lgkmcnt(8)
    v_mfma_f32_32x32x16_bf16 v[16:31], v[96:99], v[132:135], v[16:31]
    ds_read_b128 v[164:167], v15 offset:9216
    ds_read_b128 v[40:43], v7 offset:4096
    s_waitcnt lgkmcnt(9)
    v_mfma_f32_32x32x16_bf16 v[16:31], v[100:103], v[136:139], v[16:31]
    ds_read_b128 v[128:131], v6 offset:0
    ds_read_b128 v[44:47], v7 offset:8192
    s_waitcnt lgkmcnt(10)
    v_mfma_f32_32x32x16_bf16 v[16:31], v[104:107], v[140:143], v[16:31]
    ds_read_b128 v[132:135], v6 offset:1024
    ds_read_b128 v[48:51], v7 offset:12288
    s_waitcnt lgkmcnt(11)
    v_mfma_f32_32x32x16_bf16 v[16:31], v[108:111], v[144:147], v[16:31]
    ds_read_b128 v[136:139], v6 offset:2048
    ds_read_b128 v[52:55], v7 offset:16384
    s_waitcnt lgkmcnt(12)
    v_mfma_f32_32x32x16_bf16 v[16:31], v[112:115], v[148:151], v[16:31]
    ds_read_b128 v[140:143], v6 offset:3072
    ds_read_b128 v[56:59], v7 offset:20480
    s_waitcnt lgkmcnt(10)
    v_mfma_f32_32x32x16_bf16 v[16:31], v[36:39], v[152:155], v[16:31]
    ds_read_b128 v[144:147], v6 offset:4096
    ds_read_b128 v[60:63], v7 offset:24576
    s_waitcnt lgkmcnt(10)
    v_mfma_f32_32x32x16_bf16 v[16:31], v[40:43], v[156:159], v[16:31]
    ds_read_b128 v[148:151], v6 offset:5120
    ds_read_b128 v[64:67], v7 offset:28672
    s_waitcnt lgkmcnt(10)
    v_mfma_f32_32x32x16_bf16 v[16:31], v[44:47], v[160:163], v[16:31]
    ds_read_b128 v[152:155], v6 offset:6144
    ds_read_b128 v[68:71], v7 offset:32768
    s_waitcnt lgkmcnt(10)
    v_mfma_f32_32x32x16_bf16 v[16:31], v[48:51], v[164:167], v[16:31]
    ds_read_b128 v[156:159], v6 offset:7168
    ds_read_b128 v[72:75], v7 offset:36864
    s_waitcnt lgkmcnt(10)
    v_mfma_f32_32x32x16_bf16 v[16:31], v[52:55], v[128:131], v[16:31]
    ds_read_b128 v[160:163], v6 offset:8192
    ds_read_b128 v[76:79], v7 offset:40960
    s_waitcnt lgkmcnt(10)
    v_mfma_f32_32x32x16_bf16 v[16:31], v[56:59], v[132:135], v[16:31]
    ds_read_b128 v[164:167], v6 offset:9216
    ds_read_b128 v[96:99], v7 offset:45056
    s_waitcnt lgkmcnt(10)
    v_mfma_f32_32x32x16_bf16 v[16:31], v[60:63], v[136:139], v[16:31]
    ds_read_b128 v[100:103], v7 offset:49152
    s_waitcnt lgkmcnt(9)
    v_mfma_f32_32x32x16_bf16 v[16:31], v[64:67], v[140:143], v[16:31]
    s_waitcnt lgkmcnt(7)
    v_mfma_f32_32x32x16_bf16 v[16:31], v[68:71], v[144:147], v[16:31]
    s_waitcnt lgkmcnt(5)
    v_mfma_f32_32x32x16_bf16 v[16:31], v[72:75], v[148:151], v[16:31]
    s_waitcnt lgkmcnt(3)
    v_mfma_f32_32x32x16_bf16 v[16:31], v[76:79], v[152:155], v[16:31]
    s_waitcnt lgkmcnt(1)
    v_mfma_f32_32x32x16_bf16 v[16:31], v[96:99], v[156:159], v[16:31]
    s_waitcnt lgkmcnt(0)
    v_mfma_f32_32x32x16_bf16 v[16:31], v[100:103], v[160:163], v[16:31]
    s_waitcnt vmcnt(0)
    v_mfma_f32_32x32x16_bf16 v[16:31], v[32:35], v[164:167], v[16:31]
L_t_b:
    ds_read_b32 v3, v0 offset:84
    s_waitcnt lgkmcnt(0)
    v_readfirstlane_b32 s27, v3
    s_cmp_ge_u32 s27, 4
    s_cbranch_scc1 L_t_b_ok
    s_sleep 0
    s_branch L_t_b
L_t_b_ok:
    ds_read_b128 v[96:99], v10 offset:0
    ds_read_b128 v[100:103], v10 offset:1024
    ds_read_b128 v[104:107], v10 offset:2048
    ds_read_b128 v[108:111], v10 offset:3072
    v_lshlrev_b32 v112, 16, v12
    v_and_b32 v113, 0xffff0000, v12
    v_lshlrev_b32 v114, 16, v13
    v_and_b32 v115, 0xffff0000, v13
    v_cvt_pk_bf16_f32 v120, v16, v17
    v_cvt_pk_bf16_f32 v121, v18, v19
    v_cvt_pk_bf16_f32 v122, v20, v21
    v_cvt_pk_bf16_f32 v123, v22, v23
    v_cvt_pk_bf16_f32 v124, v24, v25
    v_cvt_pk_bf16_f32 v125, v26, v27
    v_cvt_pk_bf16_f32 v126, v28, v29
    v_cvt_pk_bf16_f32 v127, v30, v31
    buffer_store_dwordx4 v[120:123], v1, s[56:59], s39 offen
    buffer_store_dwordx4 v[124:127], v1, s[56:59], s39 offen offset:16
    s_waitcnt lgkmcnt(0)
    v_add_f32 v112, v112, v96
    v_add_f32 v113, v113, v97
    v_add_f32 v114, v114, v98
    v_add_f32 v115, v115, v99
    v_add_f32 v112, v112, v100
    v_add_f32 v113, v113, v101
    v_add_f32 v114, v114, v102
    v_add_f32 v115, v115, v103
    v_add_f32 v112, v112, v104
    v_add_f32 v113, v113, v105
    v_add_f32 v114, v114, v106
    v_add_f32 v115, v115, v107
    v_add_f32 v112, v112, v108
    v_add_f32 v113, v113, v109
    v_add_f32 v114, v114, v110
    v_add_f32 v115, v115, v111
    v_cvt_pk_bf16_f32 v116, v112, v113
    v_cvt_pk_bf16_f32 v117, v114, v115
    buffer_store_dwordx2 v[116:117], v1, s[56:59], s38 offen
    s_endpgm
L_a_fallback:
    s_mov_b32 s20, 14417920
    s_mov_b32 s24, 0
    v_mov_b32 v2, 0xff800000
L_a_fb1:
    buffer_load_dwordx4 v[120:123], v14, s[8:11], s20 offen sc1
    buffer_load_dwordx2 v[124:125], v15, s[8:11], s20 offen sc1
    s_waitcnt vmcnt(0)
    v_mfma_f32_32x32x16_bf16 v[32:47], v[120:123], v[4:7], 0
    v_mfma_f32_32x32x8_bf16 v[32:47], v[124:125], v[8:9], v[32:47]
    s_nop 15
    v_max3_f32 v2, v32, v33, v2
    v_max3_f32 v2, v34, v35, v2
    v_max3_f32 v2, v36, v37, v2
    v_max3_f32 v2, v38, v39, v2
    v_max3_f32 v2, v40, v41, v2
    v_max3_f32 v2, v42, v43, v2
    v_max3_f32 v2, v44, v45, v2
    v_max3_f32 v2, v46, v47, v2
    s_add_u32 s20, s20, 2624
    s_add_u32 s24, s24, 1
    s_cmp_lt_u32 s24, 64
    s_cbranch_scc1 L_a_fb1
    v_mov_b32 v3, v2
    s_nop 1
    v_permlane32_swap_b32 v3, v2
    s_nop 1
    v_max_f32 v2, v2, v3
    v_sub_f32 v16, 0, v2
    v_mov_b32 v17, v16
    v_mov_b32 v18, v16
    v_mov_b32 v19, v16
    v_mov_b32 v20, v16
    v_mov_b32 v21, v16
    v_mov_b32 v22, v16
    v_mov_b32 v23, v16
    v_mov_b32 v24, v16
    v_mov_b32 v25, v16
    v_mov_b32 v26, v16
    v_mov_b32 v27, v16
    v_mov_b32 v28, v16
    v_mov_b32 v29, v16
    v_mov_b32 v30, v16
    v_mov_b32 v31, v16
    v_mov_b32 v64, 0
    v_mov_b32 v65, 0
    v_mov_b32 v66, 0
    v_mov_b32 v67, 0
    v_mov_b32 v68, 0
    v_mov_b32 v69, 0
    v_mov_b32 v70, 0
    v_mov_b32 v71, 0
    v_mov_b32 v72, 0
    v_mov_b32 v73, 0
    v_mov_b32 v74, 0
    v_mov_b32 v75, 0
    v_mov_b32 v76, 0
    v_mov_b32 v77, 0
    v_mov_b32 v78, 0
    v_mov_b32 v79, 0
    s_mov_b32 s20, 14417920
    s_mov_b32 s24, 0
L_a_fb2:
    s_add_u32 s21, s20, 2624
    s_add_u32 s22, s20, 5248
    buffer_load_dwordx4 v[120:123], v14, s[8:11], s20 offen sc1
    buffer_load_dwordx2 v[124:125], v15, s[8:11], s20 offen sc1
    buffer_load_dwordx4 v[92:95], v13, s[8:11], s21 offen offset:672 sc1
    buffer_load_dwordx4 v[88:91], v13, s[8:11], s22 offen sc1
    s_waitcnt vmcnt(0)
    v_mfma_f32_32x32x16_bf16 v[32:47], v[120:123], v[4:7], v[16:31]
    v_mfma_f32_32x32x8_bf16 v[32:47], v[124:125], v[8:9], v[32:47]
    s_nop 15
    v_exp_f32 v32, v32
    v_exp_f32 v33, v33
    v_exp_f32 v34, v34
    v_exp_f32 v35, v35
    v_exp_f32 v36, v36
    v_exp_f32 v37, v37
    v_exp_f32 v38, v38
    v_exp_f32 v39, v39
    v_exp_f32 v40, v40
    v_exp_f32 v41, v41
    v_exp_f32 v42, v42
    v_exp_f32 v43, v43
    v_exp_f32 v44, v44
    v_exp_f32 v45, v45
    v_exp_f32 v46, v46
    v_exp_f32 v47, v47
    s_nop 0
    v_cvt_pk_bf16_f32 v80, v32, v33
    v_cvt_pk_bf16_f32 v81, v34, v35
    v_cvt_pk_bf16_f32 v82, v36, v37
    v_cvt_pk_bf16_f32 v83, v38, v39
    v_cvt_pk_bf16_f32 v84, v40, v41
    v_cvt_pk_bf16_f32 v85, v42, v43
    v_cvt_pk_bf16_f32 v86, v44, v45
    v_cvt_pk_bf16_f32 v87, v46, v47
    s_nop 1
    v_mfma_f32_32x32x16_bf16 v[64:79], v[92:95], v[80:83], v[64:79]
    v_mfma_f32_32x32x16_bf16 v[64:79], v[88:91], v[84:87], v[64:79]
    s_add_u32 s20, s20, 2624
    s_add_u32 s24, s24, 1
    s_cmp_lt_u32 s24, 64
    s_nop 15
    s_cbranch_scc1 L_a_fb2
    s_branch L_a_fin
L_h_start:
    s_sub_u32 s21, s21, 28
    s_lshl_b32 s21, s21, 3
    s_add_u32 s21, s21, s20
    v_lshrrev_b32 v2, 3, v1
    v_and_b32 v3, 7, v1
    s_cmp_eq_u32 s7, 2
    s_cbranch_scc1 L_h_cs
    v_mul_u32_u24 v4, 1280, v2
    v_lshl_add_u32 v4, v3, 4, v4
    s_lshl_b32 s22, s21, 3
    s_add_u32 s22, s22, s66
    s_mul_i32 s30, s22, 10240
    s_waitcnt lgkmcnt(0)
    s_mov_b32 s12, s44
    s_mov_b32 s13, s45
    s_mov_b32 s14, 2621440
    s_mov_b32 s15, 0x00020000
    buffer_load_dwordx4 v[48:51], v4, s[12:15], s30 offen offset:0
    buffer_load_dwordx4 v[52:55], v4, s[12:15], s30 offen offset:128
    buffer_load_dwordx4 v[56:59], v4, s[12:15], s30 offen offset:256
    buffer_load_dwordx4 v[60:63], v4, s[12:15], s30 offen offset:384
    buffer_load_dwordx4 v[64:67], v4, s[12:15], s30 offen offset:512
    buffer_load_dwordx4 v[68:71], v4, s[12:15], s30 offen offset:640
    buffer_load_dwordx4 v[72:75], v4, s[12:15], s30 offen offset:768
    buffer_load_dwordx4 v[76:79], v4, s[12:15], s30 offen offset:896
    buffer_load_dwordx4 v[80:83], v4, s[12:15], s30 offen offset:1024
    buffer_load_dwordx4 v[84:87], v4, s[12:15], s30 offen offset:1152
    s_mov_b32 s8, s4
    s_mov_b32 s9, s5
    s_mov_b32 s10, 15204352
    s_mov_b32 s11, 0x00020000
    s_mov_b32 s16, s62
    s_mov_b32 s17, s63
    s_mov_b32 s18, 256
    s_mov_b32 s19, 0x00020000
    v_mov_b32 v44, 0
    s_mov_b32 s28, 0
L_h_tag0:
    buffer_load_dword v46, v44, s[16:19], 0 offen sc1
    s_add_u32 s28, s28, 1
    s_waitcnt vmcnt(0)
    v_readfirstlane_b32 s64, v46
    s_cmp_lg_u32 s64, 0
    s_cbranch_scc1 L_h_tag0_ok
    s_sleep 2
    s_cmp_lt_u32 s28, 131072
    s_cbranch_scc1 L_h_tag0
L_h_tag0_ok:
    s_cmp_lg_u32 s66, 4
    s_cbranch_scc1 L_h_nox
    s_lshr_b32 s30, s3, 2
    s_mul_i32 s30, s30, 4224
    s_add_u32 s30, s30, 14781440
    s_and_b32 s31, s3, 3
    s_lshl_b32 s31, s31, 3
    s_add_u32 s30, s30, s31
    v_mov_b32 v46, s64
    v_mov_b32 v47, s54
    s_mov_b64 exec, 1
    buffer_store_dwordx2 v[46:47], off, s[8:11], s30 offset:64 sc1
    s_mov_b64 exec, -1
L_h_nox:
L_h_st:
    v_mov_b32 v88, 0
    v_mov_b32 v89, 0
    v_mov_b32 v90, 0x3f803f80
    v_dot2c_f32_bf16 v88, v48, v90
    v_dot2c_f32_bf16 v89, v48, v48
    v_dot2c_f32_bf16 v88, v49, v90
    v_dot2c_f32_bf16 v89, v49, v49
    v_dot2c_f32_bf16 v88, v50, v90
    v_dot2c_f32_bf16 v89, v50, v50
    v_dot2c_f32_bf16 v88, v51, v90
    v_dot2c_f32_bf16 v89, v51, v51
    v_dot2c_f32_bf16 v88, v52, v90
    v_dot2c_f32_bf16 v89, v52, v52
    v_dot2c_f32_bf16 v88, v53, v90
    v_dot2c_f32_bf16 v89, v53, v53
    v_dot2c_f32_bf16 v88, v54, v90
    v_dot2c_f32_bf16 v89, v54, v54
    v_dot2c_f32_bf16 v88, v55, v90
    v_dot2c_f32_bf16 v89, v55, v55
    v_dot2c_f32_bf16 v88, v56, v90
    v_dot2c_f32_bf16 v89, v56, v56
    v_dot2c_f32_bf16 v88, v57, v90
    v_dot2c_f32_bf16 v89, v57, v57
    v_dot2c_f32_bf16 v88, v58, v90
    v_dot2c_f32_bf16 v89, v58, v58
    v_dot2c_f32_bf16 v88, v59, v90
    v_dot2c_f32_bf16 v89, v59, v59
    v_dot2c_f32_bf16 v88, v60, v90
    v_dot2c_f32_bf16 v89, v60, v60
    v_dot2c_f32_bf16 v88, v61, v90
    v_dot2c_f32_bf16 v89, v61, v61
    v_dot2c_f32_bf16 v88, v62, v90
    v_dot2c_f32_bf16 v89, v62, v62
    v_dot2c_f32_bf16 v88, v63, v90
    v_dot2c_f32_bf16 v89, v63, v63
    v_dot2c_f32_bf16 v88, v64, v90
    v_dot2c_f32_bf16 v89, v64, v64
    v_dot2c_f32_bf16 v88, v65, v90
    v_dot2c_f32_bf16 v89, v65, v65
    v_dot2c_f32_bf16 v88, v66, v90
    v_dot2c_f32_bf16 v89, v66, v66
    v_dot2c_f32_bf16 v88, v67, v90
    v_dot2c_f32_bf16 v89, v67, v67
    v_dot2c_f32_bf16 v88, v68, v90
    v_dot2c_f32_bf16 v89, v68, v68
    v_dot2c_f32_bf16 v88, v69, v90
    v_dot2c_f32_bf16 v89, v69, v69
    v_dot2c_f32_bf16 v88, v70, v90
    v_dot2c_f32_bf16 v89, v70, v70
    v_dot2c_f32_bf16 v88, v71, v90
    v_dot2c_f32_bf16 v89, v71, v71
    v_dot2c_f32_bf16 v88, v72, v90
    v_dot2c_f32_bf16 v89, v72, v72
    v_dot2c_f32_bf16 v88, v73, v90
    v_dot2c_f32_bf16 v89, v73, v73
    v_dot2c_f32_bf16 v88, v74, v90
    v_dot2c_f32_bf16 v89, v74, v74
    v_dot2c_f32_bf16 v88, v75, v90
    v_dot2c_f32_bf16 v89, v75, v75
    v_dot2c_f32_bf16 v88, v76, v90
    v_dot2c_f32_bf16 v89, v76, v76
    v_dot2c_f32_bf16 v88, v77, v90
    v_dot2c_f32_bf16 v89, v77, v77
    v_dot2c_f32_bf16 v88, v78, v90
    v_dot2c_f32_bf16 v89, v78, v78
    v_dot2c_f32_bf16 v88, v79, v90
    v_dot2c_f32_bf16 v89, v79, v79
    v_dot2c_f32_bf16 v88, v80, v90
    v_dot2c_f32_bf16 v89, v80, v80
    v_dot2c_f32_bf16 v88, v81, v90
    v_dot2c_f32_bf16 v89, v81, v81
    v_dot2c_f32_bf16 v88, v82, v90
    v_dot2c_f32_bf16 v89, v82, v82
    v_dot2c_f32_bf16 v88, v83, v90
    v_dot2c_f32_bf16 v89, v83, v83
    v_dot2c_f32_bf16 v88, v84, v90
    v_dot2c_f32_bf16 v89, v84, v84
    v_dot2c_f32_bf16 v88, v85, v90
    v_dot2c_f32_bf16 v89, v85, v85
    v_dot2c_f32_bf16 v88, v86, v90
    v_dot2c_f32_bf16 v89, v86, v86
    v_dot2c_f32_bf16 v88, v87, v90
    v_dot2c_f32_bf16 v89, v87, v87
    s_nop 2
    v_add_f32_dpp v88, v88, v88 quad_perm:[1,0,3,2] row_mask:0xf bank_mask:0xf
    v_add_f32_dpp v89, v89, v89 quad_perm:[1,0,3,2] row_mask:0xf bank_mask:0xf
    s_nop 1
    v_add_f32_dpp v88, v88, v88 quad_perm:[2,3,0,1] row_mask:0xf bank_mask:0xf
    v_add_f32_dpp v89, v89, v89 quad_perm:[2,3,0,1] row_mask:0xf bank_mask:0xf
    s_nop 1
    v_add_f32_dpp v88, v88, v88 row_half_mirror row_mask:0xf bank_mask:0xf
    v_add_f32_dpp v89, v89, v89 row_half_mirror row_mask:0xf bank_mask:0xf
    s_nop 1
    v_mul_f32 v88, 0x3acccccd, v88
    v_mul_f32 v89, 0x3acccccd, v89
    v_fma_f32 v89, -v88, v88, v89
    v_max_f32 v89, 0, v89
    v_cvt_pk_bf16_f32 v89, v89, v89
    v_and_b32 v89, 0xffff0000, v89
    v_add_f32 v89, 0x3727c5ac, v89
    v_cvt_pk_bf16_f32 v89, v89, v89
    v_and_b32 v89, 0xffff0000, v89
    v_sqrt_f32 v89, v89
    s_nop 0
    v_cvt_pk_bf16_f32 v93, v89, v89
    v_and_b32 v93, 0xffff0000, v93
    v_rcp_f32 v92, v93
    v_sub_f32 v88, 0, v88
    v_cvt_pk_bf16_f32 v94, v88, v88
    v_mov_b32 v95, s64
    v_lshlrev_b32 v5, 4, v2
    s_lshl_b32 s30, s22, 7
    s_add_u32 s30, s30, 14630912
    s_mov_b32 exec_lo, 0x01010101
    s_mov_b32 exec_hi, 0x01010101
    buffer_store_dwordx4 v[92:95], v5, s[8:11], s30 offen sc1
    s_mov_b64 exec, -1
    v_and_b32 v98, 0xffff0000, v94
    v_mul_f32 v98, v98, v92
    v_mov_b32 v99, v98
    v_mov_b32 v96, v92
    v_mov_b32 v97, v92
    s_lshl_b32 s30, s66, 3
    v_add_u32 v6, s30, v2
    v_bfe_u32 v7, v6, 1, 3
    v_xor_b32 v7, v7, v3
    v_lshlrev_b32 v6, 7, v6
    v_lshl_add_u32 v6, v7, 4, v6
    v_add_u32 v7, 0x10000, v6
    v_lshlrev_b32 v100, 16, v48
    v_and_b32 v101, 0xffff0000, v48
    v_lshlrev_b32 v102, 16, v49
    v_and_b32 v103, 0xffff0000, v49
    v_lshlrev_b32 v104, 16, v50
    v_and_b32 v105, 0xffff0000, v50
    v_lshlrev_b32 v106, 16, v51
    v_and_b32 v107, 0xffff0000, v51
    v_pk_fma_f32 v[100:101], v[100:101], v[96:97], v[98:99]
    v_pk_fma_f32 v[102:103], v[102:103], v[96:97], v[98:99]
    v_pk_fma_f32 v[104:105], v[104:105], v[96:97], v[98:99]
    v_pk_fma_f32 v[106:107], v[106:107], v[96:97], v[98:99]
    v_cvt_pk_bf16_f32 v48, v100, v101
    v_cvt_pk_bf16_f32 v49, v102, v103
    v_cvt_pk_bf16_f32 v50, v104, v105
    v_cvt_pk_bf16_f32 v51, v106, v107
    ds_write_b128 v6, v[48:51] offset:0
    v_lshlrev_b32 v100, 16, v52
    v_and_b32 v101, 0xffff0000, v52
    v_lshlrev_b32 v102, 16, v53
    v_and_b32 v103, 0xffff0000, v53
    v_lshlrev_b32 v104, 16, v54
    v_and_b32 v105, 0xffff0000, v54
    v_lshlrev_b32 v106, 16, v55
    v_and_b32 v107, 0xffff0000, v55
    v_pk_fma_f32 v[100:101], v[100:101], v[96:97], v[98:99]
    v_pk_fma_f32 v[102:103], v[102:103], v[96:97], v[98:99]
    v_pk_fma_f32 v[104:105], v[104:105], v[96:97], v[98:99]
    v_pk_fma_f32 v[106:107], v[106:107], v[96:97], v[98:99]
    v_cvt_pk_bf16_f32 v52, v100, v101
    v_cvt_pk_bf16_f32 v53, v102, v103
    v_cvt_pk_bf16_f32 v54, v104, v105
    v_cvt_pk_bf16_f32 v55, v106, v107
    ds_write_b128 v6, v[52:55] offset:8192
    v_lshlrev_b32 v100, 16, v56
    v_and_b32 v101, 0xffff0000, v56
    v_lshlrev_b32 v102, 16, v57
    v_and_b32 v103, 0xffff0000, v57
    v_lshlrev_b32 v104, 16, v58
    v_and_b32 v105, 0xffff0000, v58
    v_lshlrev_b32 v106, 16, v59
    v_and_b32 v107, 0xffff0000, v59
    v_pk_fma_f32 v[100:101], v[100:101], v[96:97], v[98:99]
    v_pk_fma_f32 v[102:103], v[102:103], v[96:97], v[98:99]
    v_pk_fma_f32 v[104:105], v[104:105], v[96:97], v[98:99]
    v_pk_fma_f32 v[106:107], v[106:107], v[96:97], v[98:99]
    v_cvt_pk_bf16_f32 v56, v100, v101
    v_cvt_pk_bf16_f32 v57, v102, v103
    v_cvt_pk_bf16_f32 v58, v104, v105
    v_cvt_pk_bf16_f32 v59, v106, v107
    ds_write_b128 v6, v[56:59] offset:16384
    v_lshlrev_b32 v100, 16, v60
    v_and_b32 v101, 0xffff0000, v60
    v_lshlrev_b32 v102, 16, v61
    v_and_b32 v103, 0xffff0000, v61
    v_lshlrev_b32 v104, 16, v62
    v_and_b32 v105, 0xffff0000, v62
    v_lshlrev_b32 v106, 16, v63
    v_and_b32 v107, 0xffff0000, v63
    v_pk_fma_f32 v[100:101], v[100:101], v[96:97], v[98:99]
    v_pk_fma_f32 v[102:103], v[102:103], v[96:97], v[98:99]
    v_pk_fma_f32 v[104:105], v[104:105], v[96:97], v[98:99]
    v_pk_fma_f32 v[106:107], v[106:107], v[96:97], v[98:99]
    v_cvt_pk_bf16_f32 v60, v100, v101
    v_cvt_pk_bf16_f32 v61, v102, v103
    v_cvt_pk_bf16_f32 v62, v104, v105
    v_cvt_pk_bf16_f32 v63, v106, v107
    ds_write_b128 v6, v[60:63] offset:24576
    v_lshlrev_b32 v100, 16, v64
    v_and_b32 v101, 0xffff0000, v64
    v_lshlrev_b32 v102, 16, v65
    v_and_b32 v103, 0xffff0000, v65
    v_lshlrev_b32 v104, 16, v66
    v_and_b32 v105, 0xffff0000, v66
    v_lshlrev_b32 v106, 16, v67
    v_and_b32 v107, 0xffff0000, v67
    v_pk_fma_f32 v[100:101], v[100:101], v[96:97], v[98:99]
    v_pk_fma_f32 v[102:103], v[102:103], v[96:97], v[98:99]
    v_pk_fma_f32 v[104:105], v[104:105], v[96:97], v[98:99]
    v_pk_fma_f32 v[106:107], v[106:107], v[96:97], v[98:99]
    v_cvt_pk_bf16_f32 v64, v100, v101
    v_cvt_pk_bf16_f32 v65, v102, v103
    v_cvt_pk_bf16_f32 v66, v104, v105
    v_cvt_pk_bf16_f32 v67, v106, v107
    ds_write_b128 v6, v[64:67] offset:32768
    v_lshlrev_b32 v100, 16, v68
    v_and_b32 v101, 0xffff0000, v68
    v_lshlrev_b32 v102, 16, v69
    v_and_b32 v103, 0xffff0000, v69
    v_lshlrev_b32 v104, 16, v70
    v_and_b32 v105, 0xffff0000, v70
    v_lshlrev_b32 v106, 16, v71
    v_and_b32 v107, 0xffff0000, v71
    v_pk_fma_f32 v[100:101], v[100:101], v[96:97], v[98:99]
    v_pk_fma_f32 v[102:103], v[102:103], v[96:97], v[98:99]
    v_pk_fma_f32 v[104:105], v[104:105], v[96:97], v[98:99]
    v_pk_fma_f32 v[106:107], v[106:107], v[96:97], v[98:99]
    v_cvt_pk_bf16_f32 v68, v100, v101
    v_cvt_pk_bf16_f32 v69, v102, v103
    v_cvt_pk_bf16_f32 v70, v104, v105
    v_cvt_pk_bf16_f32 v71, v106, v107
    ds_write_b128 v6, v[68:71] offset:40960
    v_lshlrev_b32 v100, 16, v72
    v_and_b32 v101, 0xffff0000, v72
    v_lshlrev_b32 v102, 16, v73
    v_and_b32 v103, 0xffff0000, v73
    v_lshlrev_b32 v104, 16, v74
    v_and_b32 v105, 0xffff0000, v74
    v_lshlrev_b32 v106, 16, v75
    v_and_b32 v107, 0xffff0000, v75
    v_pk_fma_f32 v[100:101], v[100:101], v[96:97], v[98:99]
    v_pk_fma_f32 v[102:103], v[102:103], v[96:97], v[98:99]
    v_pk_fma_f32 v[104:105], v[104:105], v[96:97], v[98:99]
    v_pk_fma_f32 v[106:107], v[106:107], v[96:97], v[98:99]
    v_cvt_pk_bf16_f32 v72, v100, v101
    v_cvt_pk_bf16_f32 v73, v102, v103
    v_cvt_pk_bf16_f32 v74, v104, v105
    v_cvt_pk_bf16_f32 v75, v106, v107
    ds_write_b128 v6, v[72:75] offset:49152
    v_lshlrev_b32 v100, 16, v76
    v_and_b32 v101, 0xffff0000, v76
    v_lshlrev_b32 v102, 16, v77
    v_and_b32 v103, 0xffff0000, v77
    v_lshlrev_b32 v104, 16, v78
    v_and_b32 v105, 0xffff0000, v78
    v_lshlrev_b32 v106, 16, v79
    v_and_b32 v107, 0xffff0000, v79
    v_pk_fma_f32 v[100:101], v[100:101], v[96:97], v[98:99]
    v_pk_fma_f32 v[102:103], v[102:103], v[96:97], v[98:99]
    v_pk_fma_f32 v[104:105], v[104:105], v[96:97], v[98:99]
    v_pk_fma_f32 v[106:107], v[106:107], v[96:97], v[98:99]
    v_cvt_pk_bf16_f32 v76, v100, v101
    v_cvt_pk_bf16_f32 v77, v102, v103
    v_cvt_pk_bf16_f32 v78, v104, v105
    v_cvt_pk_bf16_f32 v79, v106, v107
    ds_write_b128 v6, v[76:79] offset:57344
    v_lshlrev_b32 v100, 16, v80
    v_and_b32 v101, 0xffff0000, v80
    v_lshlrev_b32 v102, 16, v81
    v_and_b32 v103, 0xffff0000, v81
    v_lshlrev_b32 v104, 16, v82
    v_and_b32 v105, 0xffff0000, v82
    v_lshlrev_b32 v106, 16, v83
    v_and_b32 v107, 0xffff0000, v83
    v_pk_fma_f32 v[100:101], v[100:101], v[96:97], v[98:99]
    v_pk_fma_f32 v[102:103], v[102:103], v[96:97], v[98:99]
    v_pk_fma_f32 v[104:105], v[104:105], v[96:97], v[98:99]
    v_pk_fma_f32 v[106:107], v[106:107], v[96:97], v[98:99]
    v_cvt_pk_bf16_f32 v80, v100, v101
    v_cvt_pk_bf16_f32 v81, v102, v103
    v_cvt_pk_bf16_f32 v82, v104, v105
    v_cvt_pk_bf16_f32 v83, v106, v107
    ds_write_b128 v7, v[80:83] offset:0
    v_lshlrev_b32 v100, 16, v84
    v_and_b32 v101, 0xffff0000, v84
    v_lshlrev_b32 v102, 16, v85
    v_and_b32 v103, 0xffff0000, v85
    v_lshlrev_b32 v104, 16, v86
    v_and_b32 v105, 0xffff0000, v86
    v_lshlrev_b32 v106, 16, v87
    v_and_b32 v107, 0xffff0000, v87
    v_pk_fma_f32 v[100:101], v[100:101], v[96:97], v[98:99]
    v_pk_fma_f32 v[102:103], v[102:103], v[96:97], v[98:99]
    v_pk_fma_f32 v[104:105], v[104:105], v[96:97], v[98:99]
    v_pk_fma_f32 v[106:107], v[106:107], v[96:97], v[98:99]
    v_cvt_pk_bf16_f32 v84, v100, v101
    v_cvt_pk_bf16_f32 v85, v102, v103
    v_cvt_pk_bf16_f32 v86, v104, v105
    v_cvt_pk_bf16_f32 v87, v106, v107
    ds_write_b128 v7, v[84:87] offset:8192
    s_waitcnt lgkmcnt(0)
    s_barrier
    s_cmp_eq_u32 s7, 0
    s_cbranch_scc1 L_h_kv
    s_barrier
    s_mov_b32 s67, 0
    s_branch L_a_start
L_h_cs:
    v_mov_b32 v32, 163584
    v_mov_b32 v36, 0
    v_mov_b32 v37, 0
    v_mov_b32 v38, 0
    v_mov_b32 v39, 0
    ds_write_b128 v32, v[36:39]
    ds_write_b128 v32, v[36:39] offset:16
    ds_write_b128 v32, v[36:39] offset:32
    ds_write_b128 v32, v[36:39] offset:48
    ds_write_b128 v32, v[36:39] offset:64
    ds_write_b128 v32, v[36:39] offset:80
    s_mov_b32 s22, s21
    s_cmp_lg_u32 s6, 3
    s_cbranch_scc1 L_h_nopf
    s_getpc_b64 s[34:35]
L_h_pc:
    s_sub_u32 s34, s34, L_h_pc - L_code_begin
    s_subb_u32 s35, s35, 0
    v_lshlrev_b32 v46, 7, v1
    v_min_u32 v47, L_code_end - L_code_begin - 4, v46
    global_load_dword v160, v47, s[34:35]
    v_add_u32 v46, 8192, v46
    v_min_u32 v47, L_code_end - L_code_begin - 4, v46
    global_load_dword v161, v47, s[34:35]
    v_add_u32 v46, 8192, v46
    v_min_u32 v47, L_code_end - L_code_begin - 4, v46
    global_load_dword v162, v47, s[34:35]
    v_add_u32 v46, 8192, v46
    v_min_u32 v47, L_code_end - L_code_begin - 4, v46
    global_load_dword v163, v47, s[34:35]
    v_add_u32 v46, 8192, v46
    v_min_u32 v47, L_code_end - L_code_begin - 4, v46
    global_load_dword v164, v47, s[34:35]
    v_add_u32 v46, 8192, v46
L_h_nopf:
    s_waitcnt lgkmcnt(0)
    s_mov_b32 s8, s4
    s_mov_b32 s9, s5
    s_mov_b32 s10, 15204352
    s_mov_b32 s11, 0x00020000
    s_mov_b32 s16, s62
    s_mov_b32 s17, s63
    s_mov_b32 s18, 256
    s_mov_b32 s19, 0x00020000
    s_mov_b32 s12, s48
    s_mov_b32 s13, s49
    s_mov_b32 s14, 25600
    s_mov_b32 s15, 0x00020000
    s_lshl_b32 s30, s6, 10
    s_add_u32 m0, s30, 81920
    s_nop 0
    buffer_load_dwordx4 v30, s[12:15], s30 offen lds
    s_add_u32 s30, s30, 4096
    s_add_u32 m0, s30, 81920
    s_nop 0
    buffer_load_dwordx4 v30, s[12:15], s30 offen lds
    s_add_u32 s30, s30, 4096
    s_add_u32 m0, s30, 81920
    s_nop 0
    buffer_load_dwordx4 v30, s[12:15], s30 offen lds
    s_add_u32 s30, s30, 4096
    s_add_u32 m0, s30, 81920
    s_nop 0
    buffer_load_dwordx4 v30, s[12:15], s30 offen lds
    s_add_u32 s30, s30, 4096
    s_add_u32 m0, s30, 81920
    s_nop 0
    buffer_load_dwordx4 v30, s[12:15], s30 offen lds
    s_add_u32 s30, s30, 4096
    s_add_u32 m0, s30, 81920
    s_nop 0
    buffer_load_dwordx4 v30, s[12:15], s30 offen lds
    s_add_u32 s30, s30, 4096
    s_cmp_lg_u32 s6, 0
    s_cbranch_scc1 L_h_dma0
    s_add_u32 m0, s30, 81920
    s_nop 0
    buffer_load_dwordx4 v30, s[12:15], s30 offen lds
    s_add_u32 s30, s30, 4096
L_h_dma0:
    s_mov_b32 s12, s50
    s_mov_b32 s13, s51
    s_mov_b32 s14, 25600
    s_mov_b32 s15, 0x00020000
    s_lshl_b32 s30, s6, 10
    s_add_u32 m0, s30, 107520
    s_nop 0
    buffer_load_dwordx4 v30, s[12:15], s30 offen lds
    s_add_u32 s30, s30, 4096
    s_add_u32 m0, s30, 107520
    s_nop 0
    buffer_load_dwordx4 v30, s[12:15], s30 offen lds
    s_add_u32 s30, s30, 4096
    s_add_u32 m0, s30, 107520
    s_nop 0
    buffer_load_dwordx4 v30, s[12:15], s30 offen lds
    s_add_u32 s30, s30, 4096
    s_add_u32 m0, s30, 107520
    s_nop 0
    buffer_load_dwordx4 v30, s[12:15], s30 offen lds
    s_add_u32 s30, s30, 4096
    s_add_u32 m0, s30, 107520
    s_nop 0
    buffer_load_dwordx4 v30, s[12:15], s30 offen lds
    s_add_u32 s30, s30, 4096
    s_add_u32 m0, s30, 107520
    s_nop 0
    buffer_load_dwordx4 v30, s[12:15], s30 offen lds
    s_add_u32 s30, s30, 4096
    s_cmp_lg_u32 s6, 0
    s_cbranch_scc1 L_h_dma1
    s_add_u32 m0, s30, 107520
    s_nop 0
    buffer_load_dwordx4 v30, s[12:15], s30 offen lds
    s_add_u32 s30, s30, 4096
L_h_dma1:
    s_cmp_lt_u32 s22, 10
    s_cselect_b32 s24, s46, s56
    s_cselect_b32 s25, s47, s57
    s_mov_b32 s26, 1966080
    s_cselect_b32 s26, 819200, s26
    s_mov_b32 s27, 0x00020000
    s_mov_b32 s34, 3072
    s_cselect_b32 s34, 1280, s34
    s_sub_u32 s35, s22, 10
    s_cselect_b32 s35, s22, s35
    s_lshl_b32 s35, s35, 7
    s_mul_i32 s30, s6, 160
    s_mul_i32 s30, s30, s34
    s_add_u32 s30, s30, s35
    s_lshl_b32 s31, s34, 3
    v_mul_u32_u24 v4, s34, v2
    v_lshl_add_u32 v4, v3, 4, v4
    buffer_load_dwordx4 v[48:51], v4, s[24:27], s30 offen
    s_add_u32 s30, s30, s31
    buffer_load_dwordx4 v[52:55], v4, s[24:27], s30 offen
    s_add_u32 s30, s30, s31
    buffer_load_dwordx4 v[56:59], v4, s[24:27], s30 offen
    s_add_u32 s30, s30, s31
    buffer_load_dwordx4 v[60:63], v4, s[24:27], s30 offen
    s_add_u32 s30, s30, s31
    buffer_load_dwordx4 v[64:67], v4, s[24:27], s30 offen
    s_add_u32 s30, s30, s31
    buffer_load_dwordx4 v[68:71], v4, s[24:27], s30 offen
    s_add_u32 s30, s30, s31
    buffer_load_dwordx4 v[72:75], v4, s[24:27], s30 offen
    s_add_u32 s30, s30, s31
    buffer_load_dwordx4 v[76:79], v4, s[24:27], s30 offen
    s_add_u32 s30, s30, s31
    buffer_load_dwordx4 v[80:83], v4, s[24:27], s30 offen
    s_add_u32 s30, s30, s31
    buffer_load_dwordx4 v[84:87], v4, s[24:27], s30 offen
    s_add_u32 s30, s30, s31
    buffer_load_dwordx4 v[88:91], v4, s[24:27], s30 offen
    s_add_u32 s30, s30, s31
    buffer_load_dwordx4 v[92:95], v4, s[24:27], s30 offen
    s_add_u32 s30, s30, s31
    buffer_load_dwordx4 v[96:99], v4, s[24:27], s30 offen
    s_add_u32 s30, s30, s31
    buffer_load_dwordx4 v[100:103], v4, s[24:27], s30 offen
    s_add_u32 s30, s30, s31
    buffer_load_dwordx4 v[104:107], v4, s[24:27], s30 offen
    s_add_u32 s30, s30, s31
    buffer_load_dwordx4 v[108:111], v4, s[24:27], s30 offen
    s_add_u32 s30, s30, s31
    buffer_load_dwordx4 v[112:115], v4, s[24:27], s30 offen
    s_add_u32 s30, s30, s31
    buffer_load_dwordx4 v[116:119], v4, s[24:27], s30 offen
    s_add_u32 s30, s30, s31
    buffer_load_dwordx4 v[120:123], v4, s[24:27], s30 offen
    s_add_u32 s30, s30, s31
    buffer_load_dwordx4 v[124:127], v4, s[24:27], s30 offen
    s_add_u32 s30, s30, s31
    v_mov_b32 v44, 0
    buffer_load_dword v46, v44, s[16:19], 0 offen sc1
    s_waitcnt vmcnt(21)
    s_barrier
    s_setprio 2
    v_mov_b32 v128, 0
    v_mov_b32 v129, 0
    v_mov_b32 v130, 0
    v_mov_b32 v131, 0
    v_mov_b32 v132, 0
    v_mov_b32 v133, 0
    v_mov_b32 v134, 0
    v_mov_b32 v135, 0
    s_waitcnt vmcnt(20)
    v_lshlrev_b32 v136, 16, v48
    v_and_b32 v137, 0xffff0000, v48
    v_lshlrev_b32 v138, 16, v49
    v_and_b32 v139, 0xffff0000, v49
    v_lshlrev_b32 v140, 16, v50
    v_and_b32 v141, 0xffff0000, v50
    v_lshlrev_b32 v142, 16, v51
    v_and_b32 v143, 0xffff0000, v51
    v_add_f32 v128, v128, v136
    v_add_f32 v129, v129, v137
    v_add_f32 v130, v130, v138
    v_add_f32 v131, v131, v139
    v_add_f32 v132, v132, v140
    v_add_f32 v133, v133, v141
    v_add_f32 v134, v134, v142
    v_add_f32 v135, v135, v143
    s_waitcnt vmcnt(19)
    v_lshlrev_b32 v136, 16, v52
    v_and_b32 v137, 0xffff0000, v52
    v_lshlrev_b32 v138, 16, v53
    v_and_b32 v139, 0xffff0000, v53
    v_lshlrev_b32 v140, 16, v54
    v_and_b32 v141, 0xffff0000, v54
    v_lshlrev_b32 v142, 16, v55
    v_and_b32 v143, 0xffff0000, v55
    v_add_f32 v128, v128, v136
    v_add_f32 v129, v129, v137
    v_add_f32 v130, v130, v138
    v_add_f32 v131, v131, v139
    v_add_f32 v132, v132, v140
    v_add_f32 v133, v133, v141
    v_add_f32 v134, v134, v142
    v_add_f32 v135, v135, v143
    s_waitcnt vmcnt(18)
    v_lshlrev_b32 v136, 16, v56
    v_and_b32 v137, 0xffff0000, v56
    v_lshlrev_b32 v138, 16, v57
    v_and_b32 v139, 0xffff0000, v57
    v_lshlrev_b32 v140, 16, v58
    v_and_b32 v141, 0xffff0000, v58
    v_lshlrev_b32 v142, 16, v59
    v_and_b32 v143, 0xffff0000, v59
    v_add_f32 v128, v128, v136
    v_add_f32 v129, v129, v137
    v_add_f32 v130, v130, v138
    v_add_f32 v131, v131, v139
    v_add_f32 v132, v132, v140
    v_add_f32 v133, v133, v141
    v_add_f32 v134, v134, v142
    v_add_f32 v135, v135, v143
    s_waitcnt vmcnt(17)
    v_lshlrev_b32 v136, 16, v60
    v_and_b32 v137, 0xffff0000, v60
    v_lshlrev_b32 v138, 16, v61
    v_and_b32 v139, 0xffff0000, v61
    v_lshlrev_b32 v140, 16, v62
    v_and_b32 v141, 0xffff0000, v62
    v_lshlrev_b32 v142, 16, v63
    v_and_b32 v143, 0xffff0000, v63
    v_add_f32 v128, v128, v136
    v_add_f32 v129, v129, v137
    v_add_f32 v130, v130, v138
    v_add_f32 v131, v131, v139
    v_add_f32 v132, v132, v140
    v_add_f32 v133, v133, v141
    v_add_f32 v134, v134, v142
    v_add_f32 v135, v135, v143
    s_waitcnt vmcnt(16)
    v_lshlrev_b32 v136, 16, v64
    v_and_b32 v137, 0xffff0000, v64
    v_lshlrev_b32 v138, 16, v65
    v_and_b32 v139, 0xffff0000, v65
    v_lshlrev_b32 v140, 16, v66
    v_and_b32 v141, 0xffff0000, v66
    v_lshlrev_b32 v142, 16, v67
    v_and_b32 v143, 0xffff0000, v67
    v_add_f32 v128, v128, v136
    v_add_f32 v129, v129, v137
    v_add_f32 v130, v130, v138
    v_add_f32 v131, v131, v139
    v_add_f32 v132, v132, v140
    v_add_f32 v133, v133, v141
    v_add_f32 v134, v134, v142
    v_add_f32 v135, v135, v143
    s_waitcnt vmcnt(15)
    v_lshlrev_b32 v136, 16, v68
    v_and_b32 v137, 0xffff0000, v68
    v_lshlrev_b32 v138, 16, v69
    v_and_b32 v139, 0xffff0000, v69
    v_lshlrev_b32 v140, 16, v70
    v_and_b32 v141, 0xffff0000, v70
    v_lshlrev_b32 v142, 16, v71
    v_and_b32 v143, 0xffff0000, v71
    v_add_f32 v128, v128, v136
    v_add_f32 v129, v129, v137
    v_add_f32 v130, v130, v138
    v_add_f32 v131, v131, v139
    v_add_f32 v132, v132, v140
    v_add_f32 v133, v133, v141
    v_add_f32 v134, v134, v142
    v_add_f32 v135, v135, v143
    s_waitcnt vmcnt(14)
    v_lshlrev_b32 v136, 16, v72
    v_and_b32 v137, 0xffff0000, v72
    v_lshlrev_b32 v138, 16, v73
    v_and_b32 v139, 0xffff0000, v73
    v_lshlrev_b32 v140, 16, v74
    v_and_b32 v141, 0xffff0000, v74
    v_lshlrev_b32 v142, 16, v75
    v_and_b32 v143, 0xffff0000, v75
    v_add_f32 v128, v128, v136
    v_add_f32 v129, v129, v137
    v_add_f32 v130, v130, v138
    v_add_f32 v131, v131, v139
    v_add_f32 v132, v132, v140
    v_add_f32 v133, v133, v141
    v_add_f32 v134, v134, v142
    v_add_f32 v135, v135, v143
    s_waitcnt vmcnt(13)
    v_lshlrev_b32 v136, 16, v76
    v_and_b32 v137, 0xffff0000, v76
    v_lshlrev_b32 v138, 16, v77
    v_and_b32 v139, 0xffff0000, v77
    v_lshlrev_b32 v140, 16, v78
    v_and_b32 v141, 0xffff0000, v78
    v_lshlrev_b32 v142, 16, v79
    v_and_b32 v143, 0xffff0000, v79
    v_add_f32 v128, v128, v136
    v_add_f32 v129, v129, v137
    v_add_f32 v130, v130, v138
    v_add_f32 v131, v131, v139
    v_add_f32 v132, v132, v140
    v_add_f32 v133, v133, v141
    v_add_f32 v134, v134, v142
    v_add_f32 v135, v135, v143
    s_waitcnt vmcnt(12)
    v_lshlrev_b32 v136, 16, v80
    v_and_b32 v137, 0xffff0000, v80
    v_lshlrev_b32 v138, 16, v81
    v_and_b32 v139, 0xffff0000, v81
    v_lshlrev_b32 v140, 16, v82
    v_and_b32 v141, 0xffff0000, v82
    v_lshlrev_b32 v142, 16, v83
    v_and_b32 v143, 0xffff0000, v83
    v_add_f32 v128, v128, v136
    v_add_f32 v129, v129, v137
    v_add_f32 v130, v130, v138
    v_add_f32 v131, v131, v139
    v_add_f32 v132, v132, v140
    v_add_f32 v133, v133, v141
    v_add_f32 v134, v134, v142
    v_add_f32 v135, v135, v143
    s_waitcnt vmcnt(11)
    v_lshlrev_b32 v136, 16, v84
    v_and_b32 v137, 0xffff0000, v84
    v_lshlrev_b32 v138, 16, v85
    v_and_b32 v139, 0xffff0000, v85
    v_lshlrev_b32 v140, 16, v86
    v_and_b32 v141, 0xffff0000, v86
    v_lshlrev_b32 v142, 16, v87
    v_and_b32 v143, 0xffff0000, v87
    v_add_f32 v128, v128, v136
    v_add_f32 v129, v129, v137
    v_add_f32 v130, v130, v138
    v_add_f32 v131, v131, v139
    v_add_f32 v132, v132, v140
    v_add_f32 v133, v133, v141
    v_add_f32 v134, v134, v142
    v_add_f32 v135, v135, v143
    s_waitcnt vmcnt(10)
    v_lshlrev_b32 v136, 16, v88
    v_and_b32 v137, 0xffff0000, v88
    v_lshlrev_b32 v138, 16, v89
    v_and_b32 v139, 0xffff0000, v89
    v_lshlrev_b32 v140, 16, v90
    v_and_b32 v141, 0xffff0000, v90
    v_lshlrev_b32 v142, 16, v91
    v_and_b32 v143, 0xffff0000, v91
    v_add_f32 v128, v128, v136
    v_add_f32 v129, v129, v137
    v_add_f32 v130, v130, v138
    v_add_f32 v131, v131, v139
    v_add_f32 v132, v132, v140
    v_add_f32 v133, v133, v141
    v_add_f32 v134, v134, v142
    v_add_f32 v135, v135, v143
    s_waitcnt vmcnt(9)
    v_lshlrev_b32 v136, 16, v92
    v_and_b32 v137, 0xffff0000, v92
    v_lshlrev_b32 v138, 16, v93
    v_and_b32 v139, 0xffff0000, v93
    v_lshlrev_b32 v140, 16, v94
    v_and_b32 v141, 0xffff0000, v94
    v_lshlrev_b32 v142, 16, v95
    v_and_b32 v143, 0xffff0000, v95
    v_add_f32 v128, v128, v136
    v_add_f32 v129, v129, v137
    v_add_f32 v130, v130, v138
    v_add_f32 v131, v131, v139
    v_add_f32 v132, v132, v140
    v_add_f32 v133, v133, v141
    v_add_f32 v134, v134, v142
    v_add_f32 v135, v135, v143
    s_waitcnt vmcnt(8)
    v_lshlrev_b32 v136, 16, v96
    v_and_b32 v137, 0xffff0000, v96
    v_lshlrev_b32 v138, 16, v97
    v_and_b32 v139, 0xffff0000, v97
    v_lshlrev_b32 v140, 16, v98
    v_and_b32 v141, 0xffff0000, v98
    v_lshlrev_b32 v142, 16, v99
    v_and_b32 v143, 0xffff0000, v99
    v_add_f32 v128, v128, v136
    v_add_f32 v129, v129, v137
    v_add_f32 v130, v130, v138
    v_add_f32 v131, v131, v139
    v_add_f32 v132, v132, v140
    v_add_f32 v133, v133, v141
    v_add_f32 v134, v134, v142
    v_add_f32 v135, v135, v143
    s_waitcnt vmcnt(7)
    v_lshlrev_b32 v136, 16, v100
    v_and_b32 v137, 0xffff0000, v100
    v_lshlrev_b32 v138, 16, v101
    v_and_b32 v139, 0xffff0000, v101
    v_lshlrev_b32 v140, 16, v102
    v_and_b32 v141, 0xffff0000, v102
    v_lshlrev_b32 v142, 16, v103
    v_and_b32 v143, 0xffff0000, v103
    v_add_f32 v128, v128, v136
    v_add_f32 v129, v129, v137
    v_add_f32 v130, v130, v138
    v_add_f32 v131, v131, v139
    v_add_f32 v132, v132, v140
    v_add_f32 v133, v133, v141
    v_add_f32 v134, v134, v142
    v_add_f32 v135, v135, v143
    s_waitcnt vmcnt(6)
    v_lshlrev_b32 v136, 16, v104
    v_and_b32 v137, 0xffff0000, v104
    v_lshlrev_b32 v138, 16, v105
    v_and_b32 v139, 0xffff0000, v105
    v_lshlrev_b32 v140, 16, v106
    v_and_b32 v141, 0xffff0000, v106
    v_lshlrev_b32 v142, 16, v107
    v_and_b32 v143, 0xffff0000, v107
    v_add_f32 v128, v128, v136
    v_add_f32 v129, v129, v137
    v_add_f32 v130, v130, v138
    v_add_f32 v131, v131, v139
    v_add_f32 v132, v132, v140
    v_add_f32 v133, v133, v141
    v_add_f32 v134, v134, v142
    v_add_f32 v135, v135, v143
    s_waitcnt vmcnt(5)
    v_lshlrev_b32 v136, 16, v108
    v_and_b32 v137, 0xffff0000, v108
    v_lshlrev_b32 v138, 16, v109
    v_and_b32 v139, 0xffff0000, v109
    v_lshlrev_b32 v140, 16, v110
    v_and_b32 v141, 0xffff0000, v110
    v_lshlrev_b32 v142, 16, v111
    v_and_b32 v143, 0xffff0000, v111
    v_add_f32 v128, v128, v136
    v_add_f32 v129, v129, v137
    v_add_f32 v130, v130, v138
    v_add_f32 v131, v131, v139
    v_add_f32 v132, v132, v140
    v_add_f32 v133, v133, v141
    v_add_f32 v134, v134, v142
    v_add_f32 v135, v135, v143
    s_waitcnt vmcnt(4)
    v_lshlrev_b32 v136, 16, v112
    v_and_b32 v137, 0xffff0000, v112
    v_lshlrev_b32 v138, 16, v113
    v_and_b32 v139, 0xffff0000, v113
    v_lshlrev_b32 v140, 16, v114
    v_and_b32 v141, 0xffff0000, v114
    v_lshlrev_b32 v142, 16, v115
    v_and_b32 v143, 0xffff0000, v115
    v_add_f32 v128, v128, v136
    v_add_f32 v129, v129, v137
    v_add_f32 v130, v130, v138
    v_add_f32 v131, v131, v139
    v_add_f32 v132, v132, v140
    v_add_f32 v133, v133, v141
    v_add_f32 v134, v134, v142
    v_add_f32 v135, v135, v143
    s_waitcnt vmcnt(3)
    v_lshlrev_b32 v136, 16, v116
    v_and_b32 v137, 0xffff0000, v116
    v_lshlrev_b32 v138, 16, v117
    v_and_b32 v139, 0xffff0000, v117
    v_lshlrev_b32 v140, 16, v118
    v_and_b32 v141, 0xffff0000, v118
    v_lshlrev_b32 v142, 16, v119
    v_and_b32 v143, 0xffff0000, v119
    v_add_f32 v128, v128, v136
    v_add_f32 v129, v129, v137
    v_add_f32 v130, v130, v138
    v_add_f32 v131, v131, v139
    v_add_f32 v132, v132, v140
    v_add_f32 v133, v133, v141
    v_add_f32 v134, v134, v142
    v_add_f32 v135, v135, v143
    s_waitcnt vmcnt(2)
    v_lshlrev_b32 v136, 16, v120
    v_and_b32 v137, 0xffff0000, v120
    v_lshlrev_b32 v138, 16, v121
    v_and_b32 v139, 0xffff0000, v121
    v_lshlrev_b32 v140, 16, v122
    v_and_b32 v141, 0xffff0000, v122
    v_lshlrev_b32 v142, 16, v123
    v_and_b32 v143, 0xffff0000, v123
    v_add_f32 v128, v128, v136
    v_add_f32 v129, v129, v137
    v_add_f32 v130, v130, v138
    v_add_f32 v131, v131, v139
    v_add_f32 v132, v132, v140
    v_add_f32 v133, v133, v141
    v_add_f32 v134, v134, v142
    v_add_f32 v135, v135, v143
    s_waitcnt vmcnt(1)
    v_lshlrev_b32 v136, 16, v124
    v_and_b32 v137, 0xffff0000, v124
    v_lshlrev_b32 v138, 16, v125
    v_and_b32 v139, 0xffff0000, v125
    v_lshlrev_b32 v140, 16, v126
    v_and_b32 v141, 0xffff0000, v126
    v_lshlrev_b32 v142, 16, v127
    v_and_b32 v143, 0xffff0000, v127
    v_add_f32 v128, v128, v136
    v_add_f32 v129, v129, v137
    v_add_f32 v130, v130, v138
    v_add_f32 v131, v131, v139
    v_add_f32 v132, v132, v140
    v_add_f32 v133, v133, v141
    v_add_f32 v134, v134, v142
    v_add_f32 v135, v135, v143
    s_lshl_b32 s36, s6, 11
    s_add_u32 s36, s36, 133120
    v_lshlrev_b32 v5, 5, v1
    v_add_u32 v5, s36, v5
    ds_write_b128 v5, v[128:131]
    ds_write_b128 v5, v[132:135] offset:16
    s_waitcnt lgkmcnt(0)
    s_waitcnt vmcnt(0)
    v_readfirstlane_b32 s64, v46
    s_cmp_lg_u32 s64, 0
    s_cbranch_scc1 L_h_tag2_ok
    s_mov_b32 s28, 0
L_h_tag2:
    buffer_load_dword v46, v44, s[16:19], 0 offen sc1
    s_add_u32 s28, s28, 1
    s_waitcnt vmcnt(0)
    v_readfirstlane_b32 s64, v46
    s_cmp_lg_u32 s64, 0
    s_cbranch_scc1 L_h_tag2_ok
    s_sleep 2
    s_cmp_lt_u32 s28, 131072
    s_cbranch_scc1 L_h_tag2
L_h_tag2_ok:
    v_mov_b32 v6, 163584
    v_mov_b32 v7, 1
    s_mov_b64 exec, 1
    ds_add_rtn_u32 v8, v6, v7 offset:36
    s_waitcnt lgkmcnt(0)
    v_readfirstlane_b32 s27, v8
    s_mov_b64 exec, -1
    s_cmp_lg_u32 s27, 3
    s_cbranch_scc1 L_h_csdone
    v_lshlrev_b32 v5, 2, v1
    v_add_u32 v6, 133120, v5
    ds_read_b32 v48, v6 offset:0
    ds_read_b32 v49, v6 offset:256
    ds_read_b32 v50, v6 offset:512
    ds_read_b32 v51, v6 offset:768
    ds_read_b32 v52, v6 offset:1024
    ds_read_b32 v53, v6 offset:1280
    ds_read_b32 v54, v6 offset:1536
    ds_read_b32 v55, v6 offset:1792
    s_waitcnt lgkmcnt(4)
    ds_read_b32 v56, v6 offset:2048
    ds_read_b32 v57, v6 offset:2304
    ds_read_b32 v58, v6 offset:2560
    ds_read_b32 v59, v6 offset:2816
    ds_read_b32 v60, v6 offset:3072
    ds_read_b32 v61, v6 offset:3328
    ds_read_b32 v62, v6 offset:3584
    ds_read_b32 v63, v6 offset:3840
    s_waitcnt lgkmcnt(4)
    ds_read_b32 v64, v6 offset:4096
    ds_read_b32 v65, v6 offset:4352
    ds_read_b32 v66, v6 offset:4608
    ds_read_b32 v67, v6 offset:4864
    ds_read_b32 v68, v6 offset:5120
    ds_read_b32 v69, v6 offset:5376
    ds_read_b32 v70, v6 offset:5632
    ds_read_b32 v71, v6 offset:5888
    s_waitcnt lgkmcnt(4)
    ds_read_b32 v72, v6 offset:6144
    ds_read_b32 v73, v6 offset:6400
    ds_read_b32 v74, v6 offset:6656
    ds_read_b32 v75, v6 offset:6912
    ds_read_b32 v76, v6 offset:7168
    ds_read_b32 v77, v6 offset:7424
    ds_read_b32 v78, v6 offset:7680
    ds_read_b32 v79, v6 offset:7936
    s_waitcnt lgkmcnt(4)
    s_waitcnt lgkmcnt(0)
    v_add_f32 v48, v48, v64
    v_add_f32 v49, v49, v65
    v_add_f32 v50, v50, v66
    v_add_f32 v51, v51, v67
    v_add_f32 v52, v52, v68
    v_add_f32 v53, v53, v69
    v_add_f32 v54, v54, v70
    v_add_f32 v55, v55, v71
    v_add_f32 v56, v56, v72
    v_add_f32 v57, v57, v73
    v_add_f32 v58, v58, v74
    v_add_f32 v59, v59, v75
    v_add_f32 v60, v60, v76
    v_add_f32 v61, v61, v77
    v_add_f32 v62, v62, v78
    v_add_f32 v63, v63, v79
    v_add_f32 v48, v48, v56
    v_add_f32 v49, v49, v57
    v_add_f32 v50, v50, v58
    v_add_f32 v51, v51, v59
    v_add_f32 v52, v52, v60
    v_add_f32 v53, v53, v61
    v_add_f32 v54, v54, v62
    v_add_f32 v55, v55, v63
    v_add_f32 v48, v48, v52
    v_add_f32 v49, v49, v53
    v_add_f32 v50, v50, v54
    v_add_f32 v51, v51, v55
    v_add_f32 v48, v48, v50
    v_add_f32 v49, v49, v51
    v_add_f32 v48, v48, v49
    v_cvt_pk_bf16_f32 v49, v48, v48
    v_and_b32 v49, 0xffff0000, v49
    v_sub_f32 v49, v48, v49
    v_cvt_pk_bf16_f32 v50, v48, v49
    v_mov_b32 v51, s64
    v_lshlrev_b32 v5, 3, v1
    s_lshl_b32 s30, s22, 9
    s_add_u32 s30, s30, 14594048
    buffer_store_dwordx2 v[50:51], v5, s[8:11], s30 offen sc1
L_h_csdone:
    s_mov_b32 s39, 0
    s_barrier
    s_branch L_a_start
L_h_kv:
    s_setprio 3
    v_mov_b32 v44, 0
    s_and_b32 s30, s6, 1
    s_lshr_b32 s31, s6, 1
    s_lshl_b32 s29, s21, 1
    s_add_u32 s29, s29, s30
    v_and_b32 v2, 31, v1
    v_lshrrev_b32 v3, 5, v1
    v_bfe_u32 v40, v1, 1, 3
    v_xor_b32 v40, v40, v3
    s_lshl_b32 s30, s30, 12
    v_lshlrev_b32 v41, 7, v2
    v_add_u32 v41, s30, v41
    v_xor_b32 v42, 0, v40
    v_lshl_add_u32 v4, v42, 4, v41
    v_xor_b32 v42, 2, v40
    v_lshl_add_u32 v5, v42, 4, v41
    v_xor_b32 v42, 4, v40
    v_lshl_add_u32 v6, v42, 4, v41
    v_xor_b32 v42, 6, v40
    v_lshl_add_u32 v7, v42, 4, v41
    v_bfe_u32 v40, v1, 2, 2
    v_lshl_add_u32 v40, v3, 3, v40
    v_mul_u32_u24 v40, 40, v40
    s_mul_i32 s30, s31, 25600
    s_add_u32 s30, s30, 81920
    v_add_u32 v40, s30, v40
    v_bfe_u32 v41, v1, 4, 1
    v_and_b32 v42, 3, v1
    v_lshl_add_u32 v41, v41, 2, v42
    v_or_b32 v41, 0x0c0c0c00, v41
    s_mov_b32 s30, 0x3010200
    s_cmp_eq_u32 s31, 0
    s_cselect_b32 s30, s30, 0x3020100
    v_mov_b32 v45, s30
    v_mov_b32 v46, 0x4
    v_perm_b32 v46, v46, v45, v41
    v_lshl_add_u32 v8, v46, 3, v40
    v_mov_b32 v112, 0
    v_mov_b32 v113, 0
    v_mov_b32 v114, 0
    v_mov_b32 v115, 0
    v_mov_b32 v116, 0
    v_mov_b32 v117, 0
    v_mov_b32 v118, 0
    v_mov_b32 v119, 0
    v_mov_b32 v120, 0
    v_mov_b32 v121, 0
    v_mov_b32 v122, 0
    v_mov_b32 v123, 0
    v_mov_b32 v124, 0
    v_mov_b32 v125, 0
    v_mov_b32 v126, 0
    v_mov_b32 v127, 0
    ds_read_b128 v[48:51], v4 offset:0
    ds_read_b64_tr_b16 v[52:53], v8 offset:0
    ds_read_b64_tr_b16 v[54:55], v8 offset:160
    ds_read_b128 v[56:59], v5 offset:0
    ds_read_b64_tr_b16 v[60:61], v8 offset:640
    ds_read_b64_tr_b16 v[62:63], v8 offset:800
    ds_read_b128 v[64:67], v6 offset:0
    ds_read_b64_tr_b16 v[68:69], v8 offset:1280
    ds_read_b64_tr_b16 v[70:71], v8 offset:1440
    ds_read_b128 v[72:75], v7 offset:0
    ds_read_b64_tr_b16 v[76:77], v8 offset:1920
    ds_read_b64_tr_b16 v[78:79], v8 offset:2080
    s_mov_b32 s33, 0
    s_cbranch_scc0 L_h_vloop
L_h_kloop:
    s_waitcnt lgkmcnt(0)
    ds_read_b128 v[80:83], v4 offset:8192
    ds_read_b64_tr_b16 v[84:85], v8 offset:2560
    ds_read_b64_tr_b16 v[86:87], v8 offset:2720
    ds_read_b128 v[88:91], v5 offset:8192
    ds_read_b64_tr_b16 v[92:93], v8 offset:3200
    ds_read_b64_tr_b16 v[94:95], v8 offset:3360
    ds_read_b128 v[96:99], v6 offset:8192
    ds_read_b64_tr_b16 v[100:101], v8 offset:3840
    ds_read_b64_tr_b16 v[102:103], v8 offset:4000
    ds_read_b128 v[104:107], v7 offset:8192
    ds_read_b64_tr_b16 v[108:109], v8 offset:4480
    ds_read_b64_tr_b16 v[110:111], v8 offset:4640
    v_mfma_f32_32x32x16_bf16 v[112:127], v[52:55], v[48:51], v[112:127]
    v_mfma_f32_32x32x16_bf16 v[112:127], v[60:63], v[56:59], v[112:127]
    v_mfma_f32_32x32x16_bf16 v[112:127], v[68:71], v[64:67], v[112:127]
    v_mfma_f32_32x32x16_bf16 v[112:127], v[76:79], v[72:75], v[112:127]
    s_waitcnt lgkmcnt(0)
    ds_read_b128 v[48:51], v4 offset:16384
    ds_read_b64_tr_b16 v[52:53], v8 offset:5120
    ds_read_b64_tr_b16 v[54:55], v8 offset:5280
    ds_read_b128 v[56:59], v5 offset:16384
    ds_read_b64_tr_b16 v[60:61], v8 offset:5760
    ds_read_b64_tr_b16 v[62:63], v8 offset:5920
    ds_read_b128 v[64:67], v6 offset:16384
    ds_read_b64_tr_b16 v[68:69], v8 offset:6400
    ds_read_b64_tr_b16 v[70:71], v8 offset:6560
    ds_read_b128 v[72:75], v7 offset:16384
    ds_read_b64_tr_b16 v[76:77], v8 offset:7040
    ds_read_b64_tr_b16 v[78:79], v8 offset:7200
    v_mfma_f32_32x32x16_bf16 v[112:127], v[84:87], v[80:83], v[112:127]
    v_mfma_f32_32x32x16_bf16 v[112:127], v[92:95], v[88:91], v[112:127]
    v_mfma_f32_32x32x16_bf16 v[112:127], v[100:103], v[96:99], v[112:127]
    v_mfma_f32_32x32x16_bf16 v[112:127], v[108:111], v[104:107], v[112:127]
    v_add_u32 v4, 16384, v4
    v_add_u32 v5, 16384, v5
    v_add_u32 v6, 16384, v6
    v_add_u32 v7, 16384, v7
    v_add_u32 v8, 5120, v8
    s_add_u32 s33, s33, 1
    s_cmp_lt_u32 s33, 5
    s_cbranch_scc1 L_h_kloop
    s_waitcnt lgkmcnt(0)
    s_mul_i32 s30, s29, 2624
    s_add_u32 s30, s30, 14417920
    s_nop 7
    v_cvt_pk_bf16_f32 v48, v112, v113
    v_cvt_pk_bf16_f32 v49, v114, v115
    v_cvt_pk_bf16_f32 v50, v116, v117
    v_cvt_pk_bf16_f32 v51, v118, v119
    v_cvt_pk_bf16_f32 v52, v120, v121
    v_cvt_pk_bf16_f32 v53, v122, v123
    v_cvt_pk_bf16_f32 v54, v124, v125
    v_cvt_pk_bf16_f32 v55, v126, v127
    buffer_store_dwordx4 v[48:51], v30, s[8:11], s30 offen offset:1344 sc1
    v_lshlrev_b32 v9, 3, v1
    s_mov_b32 exec_hi, 0
    buffer_store_dwordx2 v[52:53], v9, s[8:11], s30 offen offset:2368 sc1
    s_mov_b32 exec_lo, 0
    s_mov_b32 exec_hi, -1
    s_nop 1
    v_mov_b32 v52, 0
    v_mov_b32 v53, 0
    s_mov_b64 exec, -1
    v_mov_b32 v60, 0
    v_dot2c_f32_bf16 v60, v48, v48
    v_dot2c_f32_bf16 v60, v49, v49
    v_dot2c_f32_bf16 v60, v50, v50
    v_dot2c_f32_bf16 v60, v51, v51
    v_dot2c_f32_bf16 v60, v52, v52
    v_dot2c_f32_bf16 v60, v53, v53
    s_nop 2
    v_mov_b32 v61, v60
    s_nop 1
    v_permlane32_swap_b32 v61, v60
    s_nop 1
    v_add_f32 v60, v60, v61
    s_nop 1
    v_max_f32_dpp v60, v60, v60 row_shr:1 row_mask:0xf bank_mask:0xf bound_ctrl:0
    s_nop 1
    v_max_f32_dpp v60, v60, v60 row_shr:2 row_mask:0xf bank_mask:0xf bound_ctrl:0
    s_nop 1
    v_max_f32_dpp v60, v60, v60 row_shr:4 row_mask:0xf bank_mask:0xf bound_ctrl:0
    s_nop 1
    v_max_f32_dpp v60, v60, v60 row_shr:8 row_mask:0xf bank_mask:0xf bound_ctrl:0
    s_nop 1
    v_readlane_b32 s32, v60, 15
    v_readlane_b32 s33, v60, 31
    s_nop 3
    s_max_u32 s32, s32, s33
    v_mov_b32 v60, s32
    v_mov_b32 v44, 163584
    s_mov_b64 exec, 1
    ds_max_u32 v44, v60 offset:88
    s_mov_b64 exec, -1
    s_branch L_h_kvpub
L_h_vloop:
    s_waitcnt lgkmcnt(0)
    ds_read_b128 v[80:83], v4 offset:8192
    ds_read_b64_tr_b16 v[84:85], v8 offset:2560
    ds_read_b64_tr_b16 v[86:87], v8 offset:2720
    ds_read_b128 v[88:91], v5 offset:8192
    ds_read_b64_tr_b16 v[92:93], v8 offset:3200
    ds_read_b64_tr_b16 v[94:95], v8 offset:3360
    ds_read_b128 v[96:99], v6 offset:8192
    ds_read_b64_tr_b16 v[100:101], v8 offset:3840
    ds_read_b64_tr_b16 v[102:103], v8 offset:4000
    ds_read_b128 v[104:107], v7 offset:8192
    ds_read_b64_tr_b16 v[108:109], v8 offset:4480
    ds_read_b64_tr_b16 v[110:111], v8 offset:4640
    v_mfma_f32_32x32x16_bf16 v[112:127], v[48:51], v[52:55], v[112:127]
    v_mfma_f32_32x32x16_bf16 v[112:127], v[56:59], v[60:63], v[112:127]
    v_mfma_f32_32x32x16_bf16 v[112:127], v[64:67], v[68:71], v[112:127]
    v_mfma_f32_32x32x16_bf16 v[112:127], v[72:75], v[76:79], v[112:127]
    s_waitcnt lgkmcnt(0)
    ds_read_b128 v[48:51], v4 offset:16384
    ds_read_b64_tr_b16 v[52:53], v8 offset:5120
    ds_read_b64_tr_b16 v[54:55], v8 offset:5280
    ds_read_b128 v[56:59], v5 offset:16384
    ds_read_b64_tr_b16 v[60:61], v8 offset:5760
    ds_read_b64_tr_b16 v[62:63], v8 offset:5920
    ds_read_b128 v[64:67], v6 offset:16384
    ds_read_b64_tr_b16 v[68:69], v8 offset:6400
    ds_read_b64_tr_b16 v[70:71], v8 offset:6560
    ds_read_b128 v[72:75], v7 offset:16384
    ds_read_b64_tr_b16 v[76:77], v8 offset:7040
    ds_read_b64_tr_b16 v[78:79], v8 offset:7200
    v_mfma_f32_32x32x16_bf16 v[112:127], v[80:83], v[84:87], v[112:127]
    v_mfma_f32_32x32x16_bf16 v[112:127], v[88:91], v[92:95], v[112:127]
    v_mfma_f32_32x32x16_bf16 v[112:127], v[96:99], v[100:103], v[112:127]
    v_mfma_f32_32x32x16_bf16 v[112:127], v[104:107], v[108:111], v[112:127]
    v_add_u32 v4, 16384, v4
    v_add_u32 v5, 16384, v5
    v_add_u32 v6, 16384, v6
    v_add_u32 v7, 16384, v7
    v_add_u32 v8, 5120, v8
    s_add_u32 s33, s33, 1
    s_cmp_lt_u32 s33, 5
    s_cbranch_scc1 L_h_vloop
    s_waitcnt lgkmcnt(0)
    s_mul_i32 s30, s29, 2624
    s_add_u32 s30, s30, 14417920
    s_nop 7
    v_cvt_pk_bf16_f32 v48, v112, v113
    v_cvt_pk_bf16_f32 v49, v114, v115
    v_cvt_pk_bf16_f32 v50, v116, v117
    v_cvt_pk_bf16_f32 v51, v118, v119
    v_cvt_pk_bf16_f32 v52, v120, v121
    v_cvt_pk_bf16_f32 v53, v122, v123
    v_cvt_pk_bf16_f32 v54, v124, v125
    v_cvt_pk_bf16_f32 v55, v126, v127
    s_mov_b32 exec_lo, 0x100000
    s_mov_b32 exec_hi, 0x100000
    v_mov_b32 v48, 0x3f803f80
    v_mov_b32 v49, 0x3f803f80
    v_mov_b32 v50, 0x3f803f80
    v_mov_b32 v51, 0x3f803f80
    v_mov_b32 v52, 0x3f803f80
    v_mov_b32 v53, 0x3f803f80
    v_mov_b32 v54, 0x3f803f80
    v_mov_b32 v55, 0x3f803f80
    v_mov_b32 v2, 11
    s_mov_b32 exec_lo, 0x1ff000
    s_mov_b32 exec_hi, 0x1ff000
    v_add_u32 v2, 1, v2
    s_mov_b32 exec_lo, 0x1fffff
    s_mov_b32 exec_hi, 0x1fffff
    v_mul_u32_u24 v9, 21, v3
    v_add_lshl_u32 v9, v9, v2, 4
    s_add_u32 s31, s30, 5248
    buffer_store_dwordx4 v[48:51], v9, s[8:11], s30 offen offset:3296 sc1
    buffer_store_dwordx4 v[52:55], v9, s[8:11], s31 offen sc1
    s_mov_b64 exec, -1
L_h_kvpub:
    s_waitcnt vmcnt(0)
    v_mov_b32 v44, 163584
    v_mov_b32 v45, 1
    s_mov_b64 exec, 1
    ds_add_rtn_u32 v46, v44, v45 offset:28
    s_waitcnt lgkmcnt(0)
    v_readfirstlane_b32 s27, v46
    s_mov_b64 exec, -1
    s_cmp_lg_u32 s27, 3
    s_cbranch_scc1 L_h_kvpub2
    ds_read_b32 v47, v44 offset:88
    s_lshl_b32 s30, s21, 3
    s_add_u32 s30, s30, 14680064
    v_mul_u32_u24 v45, 4224, v1
    v_mov_b32 v46, s64
    s_mov_b64 exec, 0xff
    s_waitcnt lgkmcnt(0)
    buffer_store_dwordx2 v[46:47], v45, s[8:11], s30 offen sc1
    s_mov_b64 exec, -1
L_h_kvpub2:
    s_barrier
    s_mov_b32 s67, 0
    s_branch L_a_start
L_code_end:
    s_endpgm
.section .rodata,"a"
.p2align 6
.amdhsa_kernel parallel_sum__grouped_kv_mqa__dense_activation_silu__prompt_kernel
  .amdhsa_next_free_vgpr 168
  .amdhsa_next_free_sgpr 102
  .amdhsa_accum_offset 168
  .amdhsa_group_segment_fixed_size 0
  .amdhsa_kernarg_size 88
  .amdhsa_user_sgpr_count 2
  .amdhsa_user_sgpr_kernarg_segment_ptr 1
  .amdhsa_system_sgpr_workgroup_id_x 1
  .amdhsa_float_denorm_mode_32 3
  .amdhsa_float_denorm_mode_16_64 3
.end_amdhsa_kernel
```
